```python
import torch

def _softmax(x, axis=-1):
    return torch.softmax(x, dim=axis)
def _gelu(x):
    return torch.nn.functional.gelu(x, approximate="tanh")
def _silu(x):
    return torch.nn.functional.silu(x)
def _sigmoid(x):
    return torch.sigmoid(x)
def _layernorm(x, axis=-1, eps=1e-5):
    m = x.mean(dim=axis, keepdim=True)
    v = x.var(dim=axis, keepdim=True, unbiased=False)
    return (x - m) / torch.sqrt(v + eps)
def _scatter_add(tgt, idx, src, axis=0):
    return tgt.clone().index_add_(axis, idx, src)
def _segment_sum(src, seg, n):
    out = torch.zeros((n,) + src.shape[1:], dtype=src.dtype)
    return out.index_add_(0, seg, src)
def _pad(x, pw):
    flat = tuple(v for pair in reversed(pw) for v in pair)
    return torch.nn.functional.pad(x, flat)

kernel_name = 'standalone__gqa_block_cached__near_ridge'

def setup_inputs():

    _w = (lambda a: (lambda t: t.to(torch.bfloat16) if t.is_floating_point() else t)(torch.as_tensor(a)))
    B, Sq, D = 8, 112, 512
    Hq, Hkv, Sk, Dh = 32, 32, 1024, 128
    assert Hq % Hkv == 0, (Hq, Hkv)
    return {
        "x": _w((lambda *s: torch.randn(*s, dtype=torch.bfloat16) * 0.8)(B, Sq, D)),
        "k_cache": _w((lambda *s: torch.randn(*s, dtype=torch.bfloat16) * 0.8)(B, Hkv, Sk, Dh)),
        "v_cache": _w((lambda *s: torch.randn(*s, dtype=torch.bfloat16) * 0.05)(B, Hkv, Sk, Dh)),
        "wq": _w((lambda *s: torch.randn(*s, dtype=torch.bfloat16) * 0.8)(D, Hq * Dh) * (D ** -0.5)),
        "wo": _w((lambda *s: torch.randn(*s, dtype=torch.bfloat16) * 0.05)(Hq * Dh, D) * ((Hq * Dh) ** -0.5)),
    }

def reference(x, k_cache, v_cache, wq, wo):
    B, Sq, D = x.shape
    Hq, Dh = 32, 128
    Hkv = k_cache.shape[1]
    rep = Hq // Hkv
    q = (lambda x, *d: x.permute(*d))((x @ wq).reshape(B, Sq, Hq, Dh), 0, 2, 1, 3)
    k = (lambda x, n, axis: torch.repeat_interleave(x, n, dim=axis))(k_cache, rep, axis=1)
    v = (lambda x, n, axis: torch.repeat_interleave(x, n, dim=axis))(v_cache, rep, axis=1)
    scores = torch.einsum("bhqd,bhkd->bhqk", q, k) * (Dh ** -0.5)
    p = _softmax(scores, axis=-1)
    o = torch.einsum("bhqk,bhkd->bhqd", p, v)
    return (lambda x, *d: x.permute(*d))(o, 0, 2, 1, 3).reshape(B, Sq, Hq * Dh) @ wo
```

```asm
; @launch kernel=qproj_kernel grid=(256,1,1) block=(512,1,1) lds=131072
; @launch kernel=attn_kernel grid=(256,1,1) block=(512,1,1) lds=131072
; @launch kernel=oproj_kernel grid=(256,1,1) block=(512,1,1) lds=131072
; @launch kernel=reduce_kernel grid=(512,1,1) block=(256,1,1) lds=0
.amdgcn_target "amdgcn-amd-amdhsa--gfx950"
.text
.p2align 8
qproj_kernel:
    s_cmp_ge_u32 s2, 256
    s_cbranch_scc1 qproj_kernel_done
    s_load_dwordx2 s[16:17], s[0:1], 0
    s_load_dwordx2 s[18:19], s[0:1], 24
    s_load_dwordx2 s[20:21], s[0:1], 56
    s_lshr_b32 s22, s2, 5
    v_and_b32 v1, 63, v0
    v_lshrrev_b32 v2, 6, v0
    s_nop 0
    v_readfirstlane_b32 s24, v2
    s_waitcnt lgkmcnt(0)
    s_and_b32 s23, s2, 31
    s_mul_i32 s3, s22, 114688
    s_add_u32 s16, s16, s3
    s_addc_u32 s17, s17, 0
    s_mov_b32 s4, s16
    s_and_b32 s5, s17, 0xffff
    s_mov_b32 s6, 114688
    s_mov_b32 s7, 0x00020000
    s_lshl_b32 s3, s23, 8
    s_add_u32 s18, s18, s3
    s_addc_u32 s19, s19, 0
    s_sub_u32 s25, 4194304, s3
    s_mov_b32 s8, s18
    s_and_b32 s9, s19, 0xffff
    s_mov_b32 s10, s25
    s_mov_b32 s11, 0x00020000
    s_mul_i32 s3, s22, 917504
    s_add_u32 s20, s20, s3
    s_addc_u32 s21, s21, 0
    s_mov_b32 s12, s20
    s_and_b32 s13, s21, 0xffff
    s_mov_b32 s14, 917504
    s_mov_b32 s15, 0x00020000
    s_lshl_b32 s26, s23, 8
    s_mov_b32 s27, 0
    v_lshrrev_b32 v2, 4, v1
    v_and_b32 v3, 15, v1
    s_lshl_b32 s3, s24, 4
    v_add_u32 v4, 0, v2
    v_add_u32 v4, s3, v4
    v_mul_u32_u24 v4, 8192, v4
    v_lshlrev_b32 v5, 2, v2
    v_or_b32 v5, 0, v5
    v_xor_b32 v5, v5, v3
    v_lshlrev_b32 v5, 4, v5
    v_add_u32 v6, v4, v5
    v_add_u32 v4, 4, v2
    v_add_u32 v4, s3, v4
    v_mul_u32_u24 v4, 8192, v4
    v_lshlrev_b32 v5, 2, v2
    v_or_b32 v5, 1, v5
    v_xor_b32 v5, v5, v3
    v_lshlrev_b32 v5, 4, v5
    v_add_u32 v7, v4, v5
    v_add_u32 v4, 8, v2
    v_add_u32 v4, s3, v4
    v_mul_u32_u24 v4, 8192, v4
    v_lshlrev_b32 v5, 2, v2
    v_or_b32 v5, 2, v5
    v_xor_b32 v5, v5, v3
    v_lshlrev_b32 v5, 4, v5
    v_add_u32 v8, v4, v5
    v_add_u32 v4, 12, v2
    v_add_u32 v4, s3, v4
    v_mul_u32_u24 v4, 8192, v4
    v_lshlrev_b32 v5, 2, v2
    v_or_b32 v5, 3, v5
    v_xor_b32 v5, v5, v3
    v_lshlrev_b32 v5, 4, v5
    v_add_u32 v9, v4, v5
    s_and_b32 s3, s24, 3
    s_lshl_b32 s3, s3, 5
    v_and_b32 v4, 31, v1
    v_add_u32 v4, s3, v4
    v_mul_u32_u24 v10, 1024, v4
    v_lshrrev_b32 v5, 5, v1
    v_lshlrev_b32 v11, 4, v5
    v_add_u32 v10, v10, v11
    v_add_u32 v10, s27, v10
    s_lshl_b32 s30, s24, 12
    buffer_load_dwordx4 v[32:35], v10, s[4:7], 0 offen offset:0
    buffer_load_dwordx4 v[36:39], v10, s[4:7], 0 offen offset:32
    buffer_load_dwordx4 v[40:43], v10, s[4:7], 0 offen offset:64
    buffer_load_dwordx4 v[44:47], v10, s[4:7], 0 offen offset:96
    buffer_load_dwordx4 v[48:51], v10, s[4:7], 0 offen offset:128
    buffer_load_dwordx4 v[52:55], v10, s[4:7], 0 offen offset:160
    buffer_load_dwordx4 v[56:59], v10, s[4:7], 0 offen offset:192
    buffer_load_dwordx4 v[60:63], v10, s[4:7], 0 offen offset:224
    s_mov_b32 s31, 0
    s_add_u32 m0, s30, 0
    s_nop 0
    buffer_load_dwordx4 v6, s[8:11], s31 offen lds
    s_add_u32 m0, s30, 1024
    s_nop 0
    buffer_load_dwordx4 v7, s[8:11], s31 offen lds
    s_add_u32 m0, s30, 2048
    s_nop 0
    buffer_load_dwordx4 v8, s[8:11], s31 offen lds
    s_add_u32 m0, s30, 3072
    s_nop 0
    buffer_load_dwordx4 v9, s[8:11], s31 offen lds
    buffer_load_dwordx4 v[64:67], v10, s[4:7], 0 offen offset:256
    buffer_load_dwordx4 v[68:71], v10, s[4:7], 0 offen offset:288
    buffer_load_dwordx4 v[72:75], v10, s[4:7], 0 offen offset:320
    buffer_load_dwordx4 v[76:79], v10, s[4:7], 0 offen offset:352
    buffer_load_dwordx4 v[80:83], v10, s[4:7], 0 offen offset:384
    buffer_load_dwordx4 v[84:87], v10, s[4:7], 0 offen offset:416
    buffer_load_dwordx4 v[88:91], v10, s[4:7], 0 offen offset:448
    buffer_load_dwordx4 v[92:95], v10, s[4:7], 0 offen offset:480
    s_mov_b32 s31, 1048576
    s_add_u32 m0, s30, 32768
    s_nop 0
    buffer_load_dwordx4 v6, s[8:11], s31 offen lds
    s_add_u32 m0, s30, 33792
    s_nop 0
    buffer_load_dwordx4 v7, s[8:11], s31 offen lds
    s_add_u32 m0, s30, 34816
    s_nop 0
    buffer_load_dwordx4 v8, s[8:11], s31 offen lds
    s_add_u32 m0, s30, 35840
    s_nop 0
    buffer_load_dwordx4 v9, s[8:11], s31 offen lds
    buffer_load_dwordx4 v[96:99], v10, s[4:7], 0 offen offset:512
    buffer_load_dwordx4 v[100:103], v10, s[4:7], 0 offen offset:544
    buffer_load_dwordx4 v[104:107], v10, s[4:7], 0 offen offset:576
    buffer_load_dwordx4 v[108:111], v10, s[4:7], 0 offen offset:608
    buffer_load_dwordx4 v[112:115], v10, s[4:7], 0 offen offset:640
    buffer_load_dwordx4 v[116:119], v10, s[4:7], 0 offen offset:672
    buffer_load_dwordx4 v[120:123], v10, s[4:7], 0 offen offset:704
    buffer_load_dwordx4 v[124:127], v10, s[4:7], 0 offen offset:736
    s_mov_b32 s31, 2097152
    s_add_u32 m0, s30, 65536
    s_nop 0
    buffer_load_dwordx4 v6, s[8:11], s31 offen lds
    s_add_u32 m0, s30, 66560
    s_nop 0
    buffer_load_dwordx4 v7, s[8:11], s31 offen lds
    s_add_u32 m0, s30, 67584
    s_nop 0
    buffer_load_dwordx4 v8, s[8:11], s31 offen lds
    s_add_u32 m0, s30, 68608
    s_nop 0
    buffer_load_dwordx4 v9, s[8:11], s31 offen lds
    buffer_load_dwordx4 v[128:131], v10, s[4:7], 0 offen offset:768
    buffer_load_dwordx4 v[132:135], v10, s[4:7], 0 offen offset:800
    buffer_load_dwordx4 v[136:139], v10, s[4:7], 0 offen offset:832
    buffer_load_dwordx4 v[140:143], v10, s[4:7], 0 offen offset:864
    buffer_load_dwordx4 v[144:147], v10, s[4:7], 0 offen offset:896
    buffer_load_dwordx4 v[148:151], v10, s[4:7], 0 offen offset:928
    buffer_load_dwordx4 v[152:155], v10, s[4:7], 0 offen offset:960
    buffer_load_dwordx4 v[156:159], v10, s[4:7], 0 offen offset:992
    s_mov_b32 s31, 3145728
    s_add_u32 m0, s30, 98304
    s_nop 0
    buffer_load_dwordx4 v6, s[8:11], s31 offen lds
    s_add_u32 m0, s30, 99328
    s_nop 0
    buffer_load_dwordx4 v7, s[8:11], s31 offen lds
    s_add_u32 m0, s30, 100352
    s_nop 0
    buffer_load_dwordx4 v8, s[8:11], s31 offen lds
    s_add_u32 m0, s30, 101376
    s_nop 0
    buffer_load_dwordx4 v9, s[8:11], s31 offen lds
    v_and_b32 v2, 15, v1
    v_bfe_u32 v3, v1, 4, 1
    v_lshrrev_b32 v5, 5, v1
    s_lshr_b32 s3, s24, 2
    s_lshl_b32 s3, s3, 3
    v_lshrrev_b32 v20, 2, v2
    v_lshl_add_u32 v21, v5, 3, v20
    v_add_u32 v21, 0, v21
    v_bfe_u32 v22, v2, 1, 1
    v_lshl_add_u32 v22, v3, 1, v22
    v_add_u32 v22, 0, v22
    v_add_u32 v22, s3, v22
    v_lshlrev_b32 v23, 2, v20
    v_lshl_add_u32 v23, v5, 1, v23
    v_add_u32 v23, 0, v23
    v_xor_b32 v22, v22, v23
    v_lshlrev_b32 v22, 4, v22
    v_lshl_add_u32 v22, v21, 8, v22
    v_and_b32 v23, 1, v2
    v_lshl_add_u32 v12, v23, 3, v22
    v_lshrrev_b32 v20, 2, v2
    v_lshl_add_u32 v21, v5, 3, v20
    v_add_u32 v21, 4, v21
    v_bfe_u32 v22, v2, 1, 1
    v_lshl_add_u32 v22, v3, 1, v22
    v_add_u32 v22, 0, v22
    v_add_u32 v22, s3, v22
    v_lshlrev_b32 v23, 2, v20
    v_lshl_add_u32 v23, v5, 1, v23
    v_add_u32 v23, 1, v23
    v_xor_b32 v22, v22, v23
    v_lshlrev_b32 v22, 4, v22
    v_lshl_add_u32 v22, v21, 8, v22
    v_and_b32 v23, 1, v2
    v_lshl_add_u32 v13, v23, 3, v22
    v_lshrrev_b32 v20, 2, v2
    v_lshl_add_u32 v21, v5, 3, v20
    v_add_u32 v21, 0, v21
    v_bfe_u32 v22, v2, 1, 1
    v_lshl_add_u32 v22, v3, 1, v22
    v_add_u32 v22, 4, v22
    v_add_u32 v22, s3, v22
    v_lshlrev_b32 v23, 2, v20
    v_lshl_add_u32 v23, v5, 1, v23
    v_add_u32 v23, 0, v23
    v_xor_b32 v22, v22, v23
    v_lshlrev_b32 v22, 4, v22
    v_lshl_add_u32 v22, v21, 8, v22
    v_and_b32 v23, 1, v2
    v_lshl_add_u32 v14, v23, 3, v22
    v_lshrrev_b32 v20, 2, v2
    v_lshl_add_u32 v21, v5, 3, v20
    v_add_u32 v21, 4, v21
    v_bfe_u32 v22, v2, 1, 1
    v_lshl_add_u32 v22, v3, 1, v22
    v_add_u32 v22, 4, v22
    v_add_u32 v22, s3, v22
    v_lshlrev_b32 v23, 2, v20
    v_lshl_add_u32 v23, v5, 1, v23
    v_add_u32 v23, 1, v23
    v_xor_b32 v22, v22, v23
    v_lshlrev_b32 v22, 4, v22
    v_lshl_add_u32 v22, v21, 8, v22
    v_and_b32 v23, 1, v2
    v_lshl_add_u32 v15, v23, 3, v22
    v_add_u32 v16, 0x10000, v12
    v_add_u32 v17, 0x10000, v13
    v_add_u32 v18, 0x10000, v14
    v_add_u32 v19, 0x10000, v15
    s_waitcnt vmcnt(0)
    s_barrier
    ds_read_b64_tr_b16 v[192:193], v12 offset:0
    ds_read_b64_tr_b16 v[194:195], v13 offset:0
    ds_read_b64_tr_b16 v[196:197], v14 offset:0
    ds_read_b64_tr_b16 v[198:199], v15 offset:0
    ds_read_b64_tr_b16 v[200:201], v12 offset:4096
    ds_read_b64_tr_b16 v[202:203], v13 offset:4096
    ds_read_b64_tr_b16 v[204:205], v14 offset:4096
    ds_read_b64_tr_b16 v[206:207], v15 offset:4096
    s_waitcnt lgkmcnt(4)
    v_mfma_f32_32x32x16_bf16 v[160:175], v[192:195], v[32:35], 0
    v_mfma_f32_32x32x16_bf16 v[176:191], v[196:199], v[32:35], 0
    ds_read_b64_tr_b16 v[192:193], v12 offset:8192
    ds_read_b64_tr_b16 v[194:195], v13 offset:8192
    ds_read_b64_tr_b16 v[196:197], v14 offset:8192
    ds_read_b64_tr_b16 v[198:199], v15 offset:8192
    s_waitcnt lgkmcnt(4)
    v_mfma_f32_32x32x16_bf16 v[160:175], v[200:203], v[36:39], v[160:175]
    v_mfma_f32_32x32x16_bf16 v[176:191], v[204:207], v[36:39], v[176:191]
    ds_read_b64_tr_b16 v[200:201], v12 offset:12288
    ds_read_b64_tr_b16 v[202:203], v13 offset:12288
    ds_read_b64_tr_b16 v[204:205], v14 offset:12288
    ds_read_b64_tr_b16 v[206:207], v15 offset:12288
    s_waitcnt lgkmcnt(4)
    v_mfma_f32_32x32x16_bf16 v[160:175], v[192:195], v[40:43], v[160:175]
    v_mfma_f32_32x32x16_bf16 v[176:191], v[196:199], v[40:43], v[176:191]
    ds_read_b64_tr_b16 v[192:193], v12 offset:16384
    ds_read_b64_tr_b16 v[194:195], v13 offset:16384
    ds_read_b64_tr_b16 v[196:197], v14 offset:16384
    ds_read_b64_tr_b16 v[198:199], v15 offset:16384
    s_waitcnt lgkmcnt(4)
    v_mfma_f32_32x32x16_bf16 v[160:175], v[200:203], v[44:47], v[160:175]
    v_mfma_f32_32x32x16_bf16 v[176:191], v[204:207], v[44:47], v[176:191]
    ds_read_b64_tr_b16 v[200:201], v12 offset:20480
    ds_read_b64_tr_b16 v[202:203], v13 offset:20480
    ds_read_b64_tr_b16 v[204:205], v14 offset:20480
    ds_read_b64_tr_b16 v[206:207], v15 offset:20480
    s_waitcnt lgkmcnt(4)
    v_mfma_f32_32x32x16_bf16 v[160:175], v[192:195], v[48:51], v[160:175]
    v_mfma_f32_32x32x16_bf16 v[176:191], v[196:199], v[48:51], v[176:191]
    ds_read_b64_tr_b16 v[192:193], v12 offset:24576
    ds_read_b64_tr_b16 v[194:195], v13 offset:24576
    ds_read_b64_tr_b16 v[196:197], v14 offset:24576
    ds_read_b64_tr_b16 v[198:199], v15 offset:24576
    s_waitcnt lgkmcnt(4)
    v_mfma_f32_32x32x16_bf16 v[160:175], v[200:203], v[52:55], v[160:175]
    v_mfma_f32_32x32x16_bf16 v[176:191], v[204:207], v[52:55], v[176:191]
    ds_read_b64_tr_b16 v[200:201], v12 offset:28672
    ds_read_b64_tr_b16 v[202:203], v13 offset:28672
    ds_read_b64_tr_b16 v[204:205], v14 offset:28672
    ds_read_b64_tr_b16 v[206:207], v15 offset:28672
    s_waitcnt lgkmcnt(4)
    v_mfma_f32_32x32x16_bf16 v[160:175], v[192:195], v[56:59], v[160:175]
    v_mfma_f32_32x32x16_bf16 v[176:191], v[196:199], v[56:59], v[176:191]
    ds_read_b64_tr_b16 v[192:193], v12 offset:32768
    ds_read_b64_tr_b16 v[194:195], v13 offset:32768
    ds_read_b64_tr_b16 v[196:197], v14 offset:32768
    ds_read_b64_tr_b16 v[198:199], v15 offset:32768
    s_waitcnt lgkmcnt(4)
    v_mfma_f32_32x32x16_bf16 v[160:175], v[200:203], v[60:63], v[160:175]
    v_mfma_f32_32x32x16_bf16 v[176:191], v[204:207], v[60:63], v[176:191]
    ds_read_b64_tr_b16 v[200:201], v12 offset:36864
    ds_read_b64_tr_b16 v[202:203], v13 offset:36864
    ds_read_b64_tr_b16 v[204:205], v14 offset:36864
    ds_read_b64_tr_b16 v[206:207], v15 offset:36864
    s_waitcnt lgkmcnt(4)
    v_mfma_f32_32x32x16_bf16 v[160:175], v[192:195], v[64:67], v[160:175]
    v_mfma_f32_32x32x16_bf16 v[176:191], v[196:199], v[64:67], v[176:191]
    ds_read_b64_tr_b16 v[192:193], v12 offset:40960
    ds_read_b64_tr_b16 v[194:195], v13 offset:40960
    ds_read_b64_tr_b16 v[196:197], v14 offset:40960
    ds_read_b64_tr_b16 v[198:199], v15 offset:40960
    s_waitcnt lgkmcnt(4)
    v_mfma_f32_32x32x16_bf16 v[160:175], v[200:203], v[68:71], v[160:175]
    v_mfma_f32_32x32x16_bf16 v[176:191], v[204:207], v[68:71], v[176:191]
    ds_read_b64_tr_b16 v[200:201], v12 offset:45056
    ds_read_b64_tr_b16 v[202:203], v13 offset:45056
    ds_read_b64_tr_b16 v[204:205], v14 offset:45056
    ds_read_b64_tr_b16 v[206:207], v15 offset:45056
    s_waitcnt lgkmcnt(4)
    v_mfma_f32_32x32x16_bf16 v[160:175], v[192:195], v[72:75], v[160:175]
    v_mfma_f32_32x32x16_bf16 v[176:191], v[196:199], v[72:75], v[176:191]
    ds_read_b64_tr_b16 v[192:193], v12 offset:49152
    ds_read_b64_tr_b16 v[194:195], v13 offset:49152
    ds_read_b64_tr_b16 v[196:197], v14 offset:49152
    ds_read_b64_tr_b16 v[198:199], v15 offset:49152
    s_waitcnt lgkmcnt(4)
    v_mfma_f32_32x32x16_bf16 v[160:175], v[200:203], v[76:79], v[160:175]
    v_mfma_f32_32x32x16_bf16 v[176:191], v[204:207], v[76:79], v[176:191]
    ds_read_b64_tr_b16 v[200:201], v12 offset:53248
    ds_read_b64_tr_b16 v[202:203], v13 offset:53248
    ds_read_b64_tr_b16 v[204:205], v14 offset:53248
    ds_read_b64_tr_b16 v[206:207], v15 offset:53248
    s_waitcnt lgkmcnt(4)
    v_mfma_f32_32x32x16_bf16 v[160:175], v[192:195], v[80:83], v[160:175]
    v_mfma_f32_32x32x16_bf16 v[176:191], v[196:199], v[80:83], v[176:191]
    ds_read_b64_tr_b16 v[192:193], v12 offset:57344
    ds_read_b64_tr_b16 v[194:195], v13 offset:57344
    ds_read_b64_tr_b16 v[196:197], v14 offset:57344
    ds_read_b64_tr_b16 v[198:199], v15 offset:57344
    s_waitcnt lgkmcnt(4)
    v_mfma_f32_32x32x16_bf16 v[160:175], v[200:203], v[84:87], v[160:175]
    v_mfma_f32_32x32x16_bf16 v[176:191], v[204:207], v[84:87], v[176:191]
    ds_read_b64_tr_b16 v[200:201], v12 offset:61440
    ds_read_b64_tr_b16 v[202:203], v13 offset:61440
    ds_read_b64_tr_b16 v[204:205], v14 offset:61440
    ds_read_b64_tr_b16 v[206:207], v15 offset:61440
    s_waitcnt lgkmcnt(4)
    v_mfma_f32_32x32x16_bf16 v[160:175], v[192:195], v[88:91], v[160:175]
    v_mfma_f32_32x32x16_bf16 v[176:191], v[196:199], v[88:91], v[176:191]
    ds_read_b64_tr_b16 v[192:193], v16 offset:0
    ds_read_b64_tr_b16 v[194:195], v17 offset:0
    ds_read_b64_tr_b16 v[196:197], v18 offset:0
    ds_read_b64_tr_b16 v[198:199], v19 offset:0
    s_waitcnt lgkmcnt(4)
    v_mfma_f32_32x32x16_bf16 v[160:175], v[200:203], v[92:95], v[160:175]
    v_mfma_f32_32x32x16_bf16 v[176:191], v[204:207], v[92:95], v[176:191]
    ds_read_b64_tr_b16 v[200:201], v16 offset:4096
    ds_read_b64_tr_b16 v[202:203], v17 offset:4096
    ds_read_b64_tr_b16 v[204:205], v18 offset:4096
    ds_read_b64_tr_b16 v[206:207], v19 offset:4096
    s_waitcnt lgkmcnt(4)
    v_mfma_f32_32x32x16_bf16 v[160:175], v[192:195], v[96:99], v[160:175]
    v_mfma_f32_32x32x16_bf16 v[176:191], v[196:199], v[96:99], v[176:191]
    ds_read_b64_tr_b16 v[192:193], v16 offset:8192
    ds_read_b64_tr_b16 v[194:195], v17 offset:8192
    ds_read_b64_tr_b16 v[196:197], v18 offset:8192
    ds_read_b64_tr_b16 v[198:199], v19 offset:8192
    s_waitcnt lgkmcnt(4)
    v_mfma_f32_32x32x16_bf16 v[160:175], v[200:203], v[100:103], v[160:175]
    v_mfma_f32_32x32x16_bf16 v[176:191], v[204:207], v[100:103], v[176:191]
    ds_read_b64_tr_b16 v[200:201], v16 offset:12288
    ds_read_b64_tr_b16 v[202:203], v17 offset:12288
    ds_read_b64_tr_b16 v[204:205], v18 offset:12288
    ds_read_b64_tr_b16 v[206:207], v19 offset:12288
    s_waitcnt lgkmcnt(4)
    v_mfma_f32_32x32x16_bf16 v[160:175], v[192:195], v[104:107], v[160:175]
    v_mfma_f32_32x32x16_bf16 v[176:191], v[196:199], v[104:107], v[176:191]
    ds_read_b64_tr_b16 v[192:193], v16 offset:16384
    ds_read_b64_tr_b16 v[194:195], v17 offset:16384
    ds_read_b64_tr_b16 v[196:197], v18 offset:16384
    ds_read_b64_tr_b16 v[198:199], v19 offset:16384
    s_waitcnt lgkmcnt(4)
    v_mfma_f32_32x32x16_bf16 v[160:175], v[200:203], v[108:111], v[160:175]
    v_mfma_f32_32x32x16_bf16 v[176:191], v[204:207], v[108:111], v[176:191]
    ds_read_b64_tr_b16 v[200:201], v16 offset:20480
    ds_read_b64_tr_b16 v[202:203], v17 offset:20480
    ds_read_b64_tr_b16 v[204:205], v18 offset:20480
    ds_read_b64_tr_b16 v[206:207], v19 offset:20480
    s_waitcnt lgkmcnt(4)
    v_mfma_f32_32x32x16_bf16 v[160:175], v[192:195], v[112:115], v[160:175]
    v_mfma_f32_32x32x16_bf16 v[176:191], v[196:199], v[112:115], v[176:191]
    ds_read_b64_tr_b16 v[192:193], v16 offset:24576
    ds_read_b64_tr_b16 v[194:195], v17 offset:24576
    ds_read_b64_tr_b16 v[196:197], v18 offset:24576
    ds_read_b64_tr_b16 v[198:199], v19 offset:24576
    s_waitcnt lgkmcnt(4)
    v_mfma_f32_32x32x16_bf16 v[160:175], v[200:203], v[116:119], v[160:175]
    v_mfma_f32_32x32x16_bf16 v[176:191], v[204:207], v[116:119], v[176:191]
    ds_read_b64_tr_b16 v[200:201], v16 offset:28672
    ds_read_b64_tr_b16 v[202:203], v17 offset:28672
    ds_read_b64_tr_b16 v[204:205], v18 offset:28672
    ds_read_b64_tr_b16 v[206:207], v19 offset:28672
    s_waitcnt lgkmcnt(4)
    v_mfma_f32_32x32x16_bf16 v[160:175], v[192:195], v[120:123], v[160:175]
    v_mfma_f32_32x32x16_bf16 v[176:191], v[196:199], v[120:123], v[176:191]
    ds_read_b64_tr_b16 v[192:193], v16 offset:32768
    ds_read_b64_tr_b16 v[194:195], v17 offset:32768
    ds_read_b64_tr_b16 v[196:197], v18 offset:32768
    ds_read_b64_tr_b16 v[198:199], v19 offset:32768
    s_waitcnt lgkmcnt(4)
    v_mfma_f32_32x32x16_bf16 v[160:175], v[200:203], v[124:127], v[160:175]
    v_mfma_f32_32x32x16_bf16 v[176:191], v[204:207], v[124:127], v[176:191]
    ds_read_b64_tr_b16 v[200:201], v16 offset:36864
    ds_read_b64_tr_b16 v[202:203], v17 offset:36864
    ds_read_b64_tr_b16 v[204:205], v18 offset:36864
    ds_read_b64_tr_b16 v[206:207], v19 offset:36864
    s_waitcnt lgkmcnt(4)
    v_mfma_f32_32x32x16_bf16 v[160:175], v[192:195], v[128:131], v[160:175]
    v_mfma_f32_32x32x16_bf16 v[176:191], v[196:199], v[128:131], v[176:191]
    ds_read_b64_tr_b16 v[192:193], v16 offset:40960
    ds_read_b64_tr_b16 v[194:195], v17 offset:40960
    ds_read_b64_tr_b16 v[196:197], v18 offset:40960
    ds_read_b64_tr_b16 v[198:199], v19 offset:40960
    s_waitcnt lgkmcnt(4)
    v_mfma_f32_32x32x16_bf16 v[160:175], v[200:203], v[132:135], v[160:175]
    v_mfma_f32_32x32x16_bf16 v[176:191], v[204:207], v[132:135], v[176:191]
    ds_read_b64_tr_b16 v[200:201], v16 offset:45056
    ds_read_b64_tr_b16 v[202:203], v17 offset:45056
    ds_read_b64_tr_b16 v[204:205], v18 offset:45056
    ds_read_b64_tr_b16 v[206:207], v19 offset:45056
    s_waitcnt lgkmcnt(4)
    v_mfma_f32_32x32x16_bf16 v[160:175], v[192:195], v[136:139], v[160:175]
    v_mfma_f32_32x32x16_bf16 v[176:191], v[196:199], v[136:139], v[176:191]
    ds_read_b64_tr_b16 v[192:193], v16 offset:49152
    ds_read_b64_tr_b16 v[194:195], v17 offset:49152
    ds_read_b64_tr_b16 v[196:197], v18 offset:49152
    ds_read_b64_tr_b16 v[198:199], v19 offset:49152
    s_waitcnt lgkmcnt(4)
    v_mfma_f32_32x32x16_bf16 v[160:175], v[200:203], v[140:143], v[160:175]
    v_mfma_f32_32x32x16_bf16 v[176:191], v[204:207], v[140:143], v[176:191]
    ds_read_b64_tr_b16 v[200:201], v16 offset:53248
    ds_read_b64_tr_b16 v[202:203], v17 offset:53248
    ds_read_b64_tr_b16 v[204:205], v18 offset:53248
    ds_read_b64_tr_b16 v[206:207], v19 offset:53248
    s_waitcnt lgkmcnt(4)
    v_mfma_f32_32x32x16_bf16 v[160:175], v[192:195], v[144:147], v[160:175]
    v_mfma_f32_32x32x16_bf16 v[176:191], v[196:199], v[144:147], v[176:191]
    ds_read_b64_tr_b16 v[192:193], v16 offset:57344
    ds_read_b64_tr_b16 v[194:195], v17 offset:57344
    ds_read_b64_tr_b16 v[196:197], v18 offset:57344
    ds_read_b64_tr_b16 v[198:199], v19 offset:57344
    s_waitcnt lgkmcnt(4)
    v_mfma_f32_32x32x16_bf16 v[160:175], v[200:203], v[148:151], v[160:175]
    v_mfma_f32_32x32x16_bf16 v[176:191], v[204:207], v[148:151], v[176:191]
    ds_read_b64_tr_b16 v[200:201], v16 offset:61440
    ds_read_b64_tr_b16 v[202:203], v17 offset:61440
    ds_read_b64_tr_b16 v[204:205], v18 offset:61440
    ds_read_b64_tr_b16 v[206:207], v19 offset:61440
    s_waitcnt lgkmcnt(4)
    v_mfma_f32_32x32x16_bf16 v[160:175], v[192:195], v[152:155], v[160:175]
    v_mfma_f32_32x32x16_bf16 v[176:191], v[196:199], v[152:155], v[176:191]
    s_waitcnt lgkmcnt(0)
    v_mfma_f32_32x32x16_bf16 v[160:175], v[200:203], v[156:159], v[160:175]
    v_mfma_f32_32x32x16_bf16 v[176:191], v[204:207], v[156:159], v[176:191]
    s_nop 15
    s_nop 3
    s_and_b32 s3, s24, 3
    s_lshl_b32 s3, s3, 5
    v_and_b32 v4, 31, v1
    v_add_u32 v4, s3, v4
    v_lshrrev_b32 v5, 5, v1
    s_lshr_b32 s3, s24, 2
    v_lshlrev_b32 v4, 13, v4
    v_lshl_add_u32 v4, v5, 4, v4
    s_lshl_b32 s3, s3, 7
    s_add_u32 s3, s3, s26
    v_add_u32 v4, s3, v4
    v_cvt_pk_bf16_f32 v208, v160, v161
    v_cvt_pk_bf16_f32 v209, v162, v163
    v_cvt_pk_bf16_f32 v210, v164, v165
    v_cvt_pk_bf16_f32 v211, v166, v167
    s_nop 1
    v_permlane32_swap_b32 v208, v210
    v_permlane32_swap_b32 v209, v211
    buffer_store_dwordx4 v[208:211], v4, s[12:15], 0 offen offset:0
    s_nop 1
    v_cvt_pk_bf16_f32 v208, v168, v169
    v_cvt_pk_bf16_f32 v209, v170, v171
    v_cvt_pk_bf16_f32 v210, v172, v173
    v_cvt_pk_bf16_f32 v211, v174, v175
    s_nop 1
    v_permlane32_swap_b32 v208, v210
    v_permlane32_swap_b32 v209, v211
    buffer_store_dwordx4 v[208:211], v4, s[12:15], 0 offen offset:32
    s_nop 1
    v_cvt_pk_bf16_f32 v208, v176, v177
    v_cvt_pk_bf16_f32 v209, v178, v179
    v_cvt_pk_bf16_f32 v210, v180, v181
    v_cvt_pk_bf16_f32 v211, v182, v183
    s_nop 1
    v_permlane32_swap_b32 v208, v210
    v_permlane32_swap_b32 v209, v211
    buffer_store_dwordx4 v[208:211], v4, s[12:15], 0 offen offset:64
    s_nop 1
    v_cvt_pk_bf16_f32 v208, v184, v185
    v_cvt_pk_bf16_f32 v209, v186, v187
    v_cvt_pk_bf16_f32 v210, v188, v189
    v_cvt_pk_bf16_f32 v211, v190, v191
    s_nop 1
    v_permlane32_swap_b32 v208, v210
    v_permlane32_swap_b32 v209, v211
    buffer_store_dwordx4 v[208:211], v4, s[12:15], 0 offen offset:96
    s_nop 1
qproj_kernel_done:
    s_endpgm
.section .rodata,"a"
.p2align 6
.amdhsa_kernel qproj_kernel
  .amdhsa_next_free_vgpr 216
  .amdhsa_next_free_sgpr 40
  .amdhsa_accum_offset 216
  .amdhsa_group_segment_fixed_size 0
  .amdhsa_kernarg_size 64
  .amdhsa_user_sgpr_count 2
  .amdhsa_user_sgpr_kernarg_segment_ptr 1
  .amdhsa_system_sgpr_workgroup_id_x 1
.end_amdhsa_kernel
.text
.p2align 8
attn_kernel:
    s_cmp_ge_u32 s2, 256
    s_cbranch_scc1 attn_kernel_done
    s_load_dwordx2 s[16:17], s[0:1], 8
    s_load_dwordx2 s[18:19], s[0:1], 16
    s_load_dwordx2 s[20:21], s[0:1], 56
    v_and_b32 v1, 63, v0
    v_lshrrev_b32 v2, 6, v0
    s_nop 0
    v_readfirstlane_b32 s24, v2
    s_lshr_b32 s22, s2, 5
    s_and_b32 s23, s2, 31
    s_and_b32 s25, s24, 3
    s_lshr_b32 s26, s24, 2
    s_waitcnt lgkmcnt(0)
    s_lshl_b32 s3, s2, 18
    s_add_u32 s16, s16, s3
    s_addc_u32 s17, s17, 0
    s_mov_b32 s4, s16
    s_and_b32 s5, s17, 0xffff
    s_mov_b32 s6, 262144
    s_mov_b32 s7, 0x00020000
    s_add_u32 s18, s18, s3
    s_addc_u32 s19, s19, 0
    s_mov_b32 s8, s18
    s_and_b32 s9, s19, 0xffff
    s_mov_b32 s10, 262144
    s_mov_b32 s11, 0x00020000
    s_mul_i32 s3, s22, 917504
    s_mov_b32 s28, s20
    s_mov_b32 s29, s21
    s_add_u32 s28, s28, s3
    s_addc_u32 s29, s29, 0
    s_mov_b32 s12, s28
    s_and_b32 s13, s29, 0xffff
    s_mov_b32 s14, 917504
    s_mov_b32 s15, 0x00020000
    v_lshrrev_b32 v2, 4, v1
    v_and_b32 v3, 15, v1
    s_lshl_b32 s3, s24, 3
    v_add_u32 v4, 0, v2
    v_add_u32 v4, s3, v4
    v_lshlrev_b32 v4, 8, v4
    s_lshl_b32 s27, s24, 1
    s_add_u32 s27, s27, 0
    s_and_b32 s27, s27, 3
    v_lshlrev_b32 v5, 2, v2
    v_or_b32 v5, s27, v5
    v_xor_b32 v5, v5, v3
    v_lshl_add_u32 v4, v5, 4, v4
    v_mov_b32 v6, v4
    v_add_u32 v4, 4, v2
    v_add_u32 v4, s3, v4
    v_lshlrev_b32 v4, 8, v4
    s_lshl_b32 s27, s24, 1
    s_add_u32 s27, s27, 1
    s_and_b32 s27, s27, 3
    v_lshlrev_b32 v5, 2, v2
    v_or_b32 v5, s27, v5
    v_xor_b32 v5, v5, v3
    v_lshl_add_u32 v4, v5, 4, v4
    v_subrev_u32 v4, 1024, v4
    v_mov_b32 v7, v4
    s_lshl_b32 s30, s24, 11
    s_lshl_b32 s3, s25, 5
    v_and_b32 v4, 31, v1
    v_add_u32 v4, s3, v4
    v_lshlrev_b32 v4, 13, v4
    v_lshrrev_b32 v5, 5, v1
    v_lshl_add_u32 v4, v5, 4, v4
    s_lshl_b32 s3, s23, 8
    v_add_u32 v4, s3, v4
    buffer_load_dwordx4 v[32:35], v4, s[12:15], 0 offen offset:0
    buffer_load_dwordx4 v[36:39], v4, s[12:15], 0 offen offset:32
    buffer_load_dwordx4 v[40:43], v4, s[12:15], 0 offen offset:64
    buffer_load_dwordx4 v[44:47], v4, s[12:15], 0 offen offset:96
    buffer_load_dwordx4 v[48:51], v4, s[12:15], 0 offen offset:128
    buffer_load_dwordx4 v[52:55], v4, s[12:15], 0 offen offset:160
    buffer_load_dwordx4 v[56:59], v4, s[12:15], 0 offen offset:192
    buffer_load_dwordx4 v[60:63], v4, s[12:15], 0 offen offset:224
    s_mov_b32 s31, 0
    s_mov_b32 s33, 0
    s_add_u32 m0, s33, s30
    s_nop 0
    buffer_load_dwordx4 v6, s[4:7], s31 offen lds
    buffer_load_dwordx4 v7, s[4:7], s31 offen offset:1024 lds
    s_add_u32 m0, m0, 16384
    s_nop 0
    buffer_load_dwordx4 v6, s[8:11], s31 offen lds
    buffer_load_dwordx4 v7, s[8:11], s31 offen offset:1024 lds
    s_add_u32 s31, s31, 16384
    s_add_u32 s33, s33, 32768
    s_add_u32 m0, s33, s30
    s_nop 0
    buffer_load_dwordx4 v6, s[4:7], s31 offen lds
    buffer_load_dwordx4 v7, s[4:7], s31 offen offset:1024 lds
    s_add_u32 m0, m0, 16384
    s_nop 0
    buffer_load_dwordx4 v6, s[8:11], s31 offen lds
    buffer_load_dwordx4 v7, s[8:11], s31 offen offset:1024 lds
    s_add_u32 s31, s31, 16384
    s_add_u32 s33, s33, 32768
    s_add_u32 m0, s33, s30
    s_nop 0
    buffer_load_dwordx4 v6, s[4:7], s31 offen lds
    buffer_load_dwordx4 v7, s[4:7], s31 offen offset:1024 lds
    s_add_u32 m0, m0, 16384
    s_nop 0
    buffer_load_dwordx4 v6, s[8:11], s31 offen lds
    buffer_load_dwordx4 v7, s[8:11], s31 offen offset:1024 lds
    s_add_u32 s31, s31, 16384
    s_add_u32 s33, s33, 32768
    v_and_b32 v2, 31, v1
    s_lshl_b32 s3, s26, 5
    v_add_u32 v2, s3, v2
    v_and_b32 v3, 3, v2
    v_lshlrev_b32 v3, 2, v3
    v_bfe_u32 v4, v2, 2, 2
    v_or_b32 v3, v3, v4
    v_lshrrev_b32 v5, 5, v1
    v_add_u32 v4, 0, v5
    v_xor_b32 v4, v4, v3
    v_lshlrev_b32 v4, 4, v4
    v_lshl_add_u32 v8, v2, 8, v4
    v_add_u32 v4, 2, v5
    v_xor_b32 v4, v4, v3
    v_lshlrev_b32 v4, 4, v4
    v_lshl_add_u32 v9, v2, 8, v4
    v_add_u32 v4, 4, v5
    v_xor_b32 v4, v4, v3
    v_lshlrev_b32 v4, 4, v4
    v_lshl_add_u32 v10, v2, 8, v4
    v_add_u32 v4, 6, v5
    v_xor_b32 v4, v4, v3
    v_lshlrev_b32 v4, 4, v4
    v_lshl_add_u32 v11, v2, 8, v4
    v_add_u32 v4, 8, v5
    v_xor_b32 v4, v4, v3
    v_lshlrev_b32 v4, 4, v4
    v_lshl_add_u32 v12, v2, 8, v4
    v_add_u32 v4, 10, v5
    v_xor_b32 v4, v4, v3
    v_lshlrev_b32 v4, 4, v4
    v_lshl_add_u32 v13, v2, 8, v4
    v_add_u32 v4, 12, v5
    v_xor_b32 v4, v4, v3
    v_lshlrev_b32 v4, 4, v4
    v_lshl_add_u32 v14, v2, 8, v4
    v_add_u32 v4, 14, v5
    v_xor_b32 v4, v4, v3
    v_lshlrev_b32 v4, 4, v4
    v_lshl_add_u32 v15, v2, 8, v4
    v_and_b32 v2, 15, v1
    v_bfe_u32 v3, v1, 4, 1
    v_lshrrev_b32 v27, 2, v2
    v_lshl_add_u32 v28, v5, 2, v27
    v_add_u32 v28, 0, v28
    v_add_u32 v28, s3, v28
    v_bfe_u32 v29, v2, 1, 1
    v_lshl_add_u32 v29, v3, 1, v29
    v_add_u32 v29, 0, v29
    v_lshlrev_b32 v30, 2, v27
    v_add_u32 v30, v30, v5
    v_add_u32 v30, 0, v30
    v_xor_b32 v29, v29, v30
    v_lshlrev_b32 v29, 4, v29
    v_lshl_add_u32 v29, v28, 8, v29
    v_and_b32 v30, 1, v2
    v_lshl_add_u32 v29, v30, 3, v29
    v_add_u32 v16, 16384, v29
    v_lshrrev_b32 v27, 2, v2
    v_lshl_add_u32 v28, v5, 2, v27
    v_add_u32 v28, 8, v28
    v_add_u32 v28, s3, v28
    v_bfe_u32 v29, v2, 1, 1
    v_lshl_add_u32 v29, v3, 1, v29
    v_add_u32 v29, 0, v29
    v_lshlrev_b32 v30, 2, v27
    v_add_u32 v30, v30, v5
    v_add_u32 v30, 2, v30
    v_xor_b32 v29, v29, v30
    v_lshlrev_b32 v29, 4, v29
    v_lshl_add_u32 v29, v28, 8, v29
    v_and_b32 v30, 1, v2
    v_lshl_add_u32 v29, v30, 3, v29
    v_add_u32 v17, 16384, v29
    v_lshrrev_b32 v27, 2, v2
    v_lshl_add_u32 v28, v5, 2, v27
    v_add_u32 v28, 0, v28
    v_add_u32 v28, s3, v28
    v_bfe_u32 v29, v2, 1, 1
    v_lshl_add_u32 v29, v3, 1, v29
    v_add_u32 v29, 4, v29
    v_lshlrev_b32 v30, 2, v27
    v_add_u32 v30, v30, v5
    v_add_u32 v30, 0, v30
    v_xor_b32 v29, v29, v30
    v_lshlrev_b32 v29, 4, v29
    v_lshl_add_u32 v29, v28, 8, v29
    v_and_b32 v30, 1, v2
    v_lshl_add_u32 v29, v30, 3, v29
    v_add_u32 v18, 16384, v29
    v_lshrrev_b32 v27, 2, v2
    v_lshl_add_u32 v28, v5, 2, v27
    v_add_u32 v28, 8, v28
    v_add_u32 v28, s3, v28
    v_bfe_u32 v29, v2, 1, 1
    v_lshl_add_u32 v29, v3, 1, v29
    v_add_u32 v29, 4, v29
    v_lshlrev_b32 v30, 2, v27
    v_add_u32 v30, v30, v5
    v_add_u32 v30, 2, v30
    v_xor_b32 v29, v29, v30
    v_lshlrev_b32 v29, 4, v29
    v_lshl_add_u32 v29, v28, 8, v29
    v_and_b32 v30, 1, v2
    v_lshl_add_u32 v29, v30, 3, v29
    v_add_u32 v19, 16384, v29
    v_lshrrev_b32 v27, 2, v2
    v_lshl_add_u32 v28, v5, 2, v27
    v_add_u32 v28, 0, v28
    v_add_u32 v28, s3, v28
    v_bfe_u32 v29, v2, 1, 1
    v_lshl_add_u32 v29, v3, 1, v29
    v_add_u32 v29, 8, v29
    v_lshlrev_b32 v30, 2, v27
    v_add_u32 v30, v30, v5
    v_add_u32 v30, 0, v30
    v_xor_b32 v29, v29, v30
    v_lshlrev_b32 v29, 4, v29
    v_lshl_add_u32 v29, v28, 8, v29
    v_and_b32 v30, 1, v2
    v_lshl_add_u32 v29, v30, 3, v29
    v_add_u32 v20, 16384, v29
    v_lshrrev_b32 v27, 2, v2
    v_lshl_add_u32 v28, v5, 2, v27
    v_add_u32 v28, 8, v28
    v_add_u32 v28, s3, v28
    v_bfe_u32 v29, v2, 1, 1
    v_lshl_add_u32 v29, v3, 1, v29
    v_add_u32 v29, 8, v29
    v_lshlrev_b32 v30, 2, v27
    v_add_u32 v30, v30, v5
    v_add_u32 v30, 2, v30
    v_xor_b32 v29, v29, v30
    v_lshlrev_b32 v29, 4, v29
    v_lshl_add_u32 v29, v28, 8, v29
    v_and_b32 v30, 1, v2
    v_lshl_add_u32 v29, v30, 3, v29
    v_add_u32 v21, 16384, v29
    v_lshrrev_b32 v27, 2, v2
    v_lshl_add_u32 v28, v5, 2, v27
    v_add_u32 v28, 0, v28
    v_add_u32 v28, s3, v28
    v_bfe_u32 v29, v2, 1, 1
    v_lshl_add_u32 v29, v3, 1, v29
    v_add_u32 v29, 12, v29
    v_lshlrev_b32 v30, 2, v27
    v_add_u32 v30, v30, v5
    v_add_u32 v30, 0, v30
    v_xor_b32 v29, v29, v30
    v_lshlrev_b32 v29, 4, v29
    v_lshl_add_u32 v29, v28, 8, v29
    v_and_b32 v30, 1, v2
    v_lshl_add_u32 v29, v30, 3, v29
    v_add_u32 v22, 16384, v29
    v_lshrrev_b32 v27, 2, v2
    v_lshl_add_u32 v28, v5, 2, v27
    v_add_u32 v28, 8, v28
    v_add_u32 v28, s3, v28
    v_bfe_u32 v29, v2, 1, 1
    v_lshl_add_u32 v29, v3, 1, v29
    v_add_u32 v29, 12, v29
    v_lshlrev_b32 v30, 2, v27
    v_add_u32 v30, v30, v5
    v_add_u32 v30, 2, v30
    v_xor_b32 v29, v29, v30
    v_lshlrev_b32 v29, 4, v29
    v_lshl_add_u32 v29, v28, 8, v29
    v_and_b32 v30, 1, v2
    v_lshl_add_u32 v29, v30, 3, v29
    v_add_u32 v23, 16384, v29
    v_mov_b32 v24, 0xff800000
    v_mov_b32 v25, 0
    v_mov_b32 v64, 0
    v_mov_b32 v65, 0
    v_mov_b32 v66, 0
    v_mov_b32 v67, 0
    v_mov_b32 v68, 0
    v_mov_b32 v69, 0
    v_mov_b32 v70, 0
    v_mov_b32 v71, 0
    v_mov_b32 v72, 0
    v_mov_b32 v73, 0
    v_mov_b32 v74, 0
    v_mov_b32 v75, 0
    v_mov_b32 v76, 0
    v_mov_b32 v77, 0
    v_mov_b32 v78, 0
    v_mov_b32 v79, 0
    v_mov_b32 v80, 0
    v_mov_b32 v81, 0
    v_mov_b32 v82, 0
    v_mov_b32 v83, 0
    v_mov_b32 v84, 0
    v_mov_b32 v85, 0
    v_mov_b32 v86, 0
    v_mov_b32 v87, 0
    v_mov_b32 v88, 0
    v_mov_b32 v89, 0
    v_mov_b32 v90, 0
    v_mov_b32 v91, 0
    v_mov_b32 v92, 0
    v_mov_b32 v93, 0
    v_mov_b32 v94, 0
    v_mov_b32 v95, 0
    v_mov_b32 v96, 0
    v_mov_b32 v97, 0
    v_mov_b32 v98, 0
    v_mov_b32 v99, 0
    v_mov_b32 v100, 0
    v_mov_b32 v101, 0
    v_mov_b32 v102, 0
    v_mov_b32 v103, 0
    v_mov_b32 v104, 0
    v_mov_b32 v105, 0
    v_mov_b32 v106, 0
    v_mov_b32 v107, 0
    v_mov_b32 v108, 0
    v_mov_b32 v109, 0
    v_mov_b32 v110, 0
    v_mov_b32 v111, 0
    v_mov_b32 v112, 0
    v_mov_b32 v113, 0
    v_mov_b32 v114, 0
    v_mov_b32 v115, 0
    v_mov_b32 v116, 0
    v_mov_b32 v117, 0
    v_mov_b32 v118, 0
    v_mov_b32 v119, 0
    v_mov_b32 v120, 0
    v_mov_b32 v121, 0
    v_mov_b32 v122, 0
    v_mov_b32 v123, 0
    v_mov_b32 v124, 0
    v_mov_b32 v125, 0
    v_mov_b32 v126, 0
    v_mov_b32 v127, 0
    s_mov_b32 s35, 0x3e0293ee
    s_mov_b32 s32, 0
    s_mov_b32 s34, 0
attn_kernel_loop:
    s_cmp_gt_u32 s32, 13
    s_cbranch_scc0 attn_kernel_w1
    s_waitcnt vmcnt(0)
attn_kernel_w1:
    s_waitcnt vmcnt(8)
    s_barrier
    s_cmp_ge_u32 s32, 13
    s_cbranch_scc1 attn_kernel_nodma
    s_add_u32 m0, s33, s30
    s_nop 0
    buffer_load_dwordx4 v6, s[4:7], s31 offen lds
    buffer_load_dwordx4 v7, s[4:7], s31 offen offset:1024 lds
    s_add_u32 m0, m0, 16384
    s_nop 0
    buffer_load_dwordx4 v6, s[8:11], s31 offen lds
    buffer_load_dwordx4 v7, s[8:11], s31 offen offset:1024 lds
attn_kernel_nodma:
    s_add_u32 s31, s31, 16384
    s_add_u32 s33, s33, 32768
    s_cmp_ge_u32 s33, 131072
    s_cselect_b32 s33, 0, s33
    ds_read_b128 v[152:155], v8
    ds_read_b128 v[156:159], v9
    ds_read_b128 v[160:163], v10
    ds_read_b128 v[164:167], v11
    ds_read_b128 v[168:171], v12
    ds_read_b128 v[172:175], v13
    ds_read_b128 v[176:179], v14
    ds_read_b128 v[180:183], v15
    s_waitcnt lgkmcnt(7)
    v_mfma_f32_32x32x16_bf16 v[128:143], v[152:155], v[32:35], 0
    s_waitcnt lgkmcnt(6)
    v_mfma_f32_32x32x16_bf16 v[128:143], v[156:159], v[36:39], v[128:143]
    s_waitcnt lgkmcnt(5)
    v_mfma_f32_32x32x16_bf16 v[128:143], v[160:163], v[40:43], v[128:143]
    s_waitcnt lgkmcnt(4)
    v_mfma_f32_32x32x16_bf16 v[128:143], v[164:167], v[44:47], v[128:143]
    s_waitcnt lgkmcnt(3)
    v_mfma_f32_32x32x16_bf16 v[128:143], v[168:171], v[48:51], v[128:143]
    s_waitcnt lgkmcnt(2)
    v_mfma_f32_32x32x16_bf16 v[128:143], v[172:175], v[52:55], v[128:143]
    s_waitcnt lgkmcnt(1)
    v_mfma_f32_32x32x16_bf16 v[128:143], v[176:179], v[56:59], v[128:143]
    s_waitcnt lgkmcnt(0)
    v_mfma_f32_32x32x16_bf16 v[128:143], v[180:183], v[60:63], v[128:143]
    ds_read_b64_tr_b16 v[184:185], v16 offset:0
    ds_read_b64_tr_b16 v[186:187], v17 offset:0
    ds_read_b64_tr_b16 v[188:189], v18 offset:0
    ds_read_b64_tr_b16 v[190:191], v19 offset:0
    ds_read_b64_tr_b16 v[192:193], v20 offset:0
    ds_read_b64_tr_b16 v[194:195], v21 offset:0
    ds_read_b64_tr_b16 v[196:197], v22 offset:0
    ds_read_b64_tr_b16 v[198:199], v23 offset:0
    ds_read_b64_tr_b16 v[200:201], v16 offset:4096
    ds_read_b64_tr_b16 v[202:203], v17 offset:4096
    ds_read_b64_tr_b16 v[204:205], v18 offset:4096
    ds_read_b64_tr_b16 v[206:207], v19 offset:4096
    ds_read_b64_tr_b16 v[208:209], v20 offset:4096
    ds_read_b64_tr_b16 v[210:211], v21 offset:4096
    ds_read_b64_tr_b16 v[212:213], v22 offset:4096
    ds_read_b64_tr_b16 v[214:215], v23 offset:4096
    s_nop 7
    v_max3_f32 v27, v128, v129, v130
    v_max3_f32 v27, v27, v131, v132
    v_max3_f32 v27, v27, v133, v134
    v_max3_f32 v27, v27, v135, v136
    v_max3_f32 v27, v27, v137, v138
    v_max3_f32 v27, v27, v139, v140
    v_max3_f32 v27, v27, v141, v142
    v_max_f32 v27, v27, v143
    v_mov_b32 v28, v27
    s_nop 1
    v_permlane32_swap_b32 v27, v28
    v_max_f32 v27, v27, v28
    v_max_f32 v27, v27, v24
    v_cmp_gt_f32 vcc, v27, v24
    s_nop 1
    s_cbranch_vccz attn_kernel_noscale
    v_sub_f32 v28, v24, v27
    v_mul_f32 v28, s35, v28
    v_exp_f32 v28, v28
    s_nop 0
    v_mul_f32 v25, v25, v28
    v_mul_f32 v64, v64, v28
    v_mul_f32 v65, v65, v28
    v_mul_f32 v66, v66, v28
    v_mul_f32 v67, v67, v28
    v_mul_f32 v68, v68, v28
    v_mul_f32 v69, v69, v28
    v_mul_f32 v70, v70, v28
    v_mul_f32 v71, v71, v28
    v_mul_f32 v72, v72, v28
    v_mul_f32 v73, v73, v28
    v_mul_f32 v74, v74, v28
    v_mul_f32 v75, v75, v28
    v_mul_f32 v76, v76, v28
    v_mul_f32 v77, v77, v28
    v_mul_f32 v78, v78, v28
    v_mul_f32 v79, v79, v28
    v_mul_f32 v80, v80, v28
    v_mul_f32 v81, v81, v28
    v_mul_f32 v82, v82, v28
    v_mul_f32 v83, v83, v28
    v_mul_f32 v84, v84, v28
    v_mul_f32 v85, v85, v28
    v_mul_f32 v86, v86, v28
    v_mul_f32 v87, v87, v28
    v_mul_f32 v88, v88, v28
    v_mul_f32 v89, v89, v28
    v_mul_f32 v90, v90, v28
    v_mul_f32 v91, v91, v28
    v_mul_f32 v92, v92, v28
    v_mul_f32 v93, v93, v28
    v_mul_f32 v94, v94, v28
    v_mul_f32 v95, v95, v28
    v_mul_f32 v96, v96, v28
    v_mul_f32 v97, v97, v28
    v_mul_f32 v98, v98, v28
    v_mul_f32 v99, v99, v28
    v_mul_f32 v100, v100, v28
    v_mul_f32 v101, v101, v28
    v_mul_f32 v102, v102, v28
    v_mul_f32 v103, v103, v28
    v_mul_f32 v104, v104, v28
    v_mul_f32 v105, v105, v28
    v_mul_f32 v106, v106, v28
    v_mul_f32 v107, v107, v28
    v_mul_f32 v108, v108, v28
    v_mul_f32 v109, v109, v28
    v_mul_f32 v110, v110, v28
    v_mul_f32 v111, v111, v28
    v_mul_f32 v112, v112, v28
    v_mul_f32 v113, v113, v28
    v_mul_f32 v114, v114, v28
    v_mul_f32 v115, v115, v28
    v_mul_f32 v116, v116, v28
    v_mul_f32 v117, v117, v28
    v_mul_f32 v118, v118, v28
    v_mul_f32 v119, v119, v28
    v_mul_f32 v120, v120, v28
    v_mul_f32 v121, v121, v28
    v_mul_f32 v122, v122, v28
    v_mul_f32 v123, v123, v28
    v_mul_f32 v124, v124, v28
    v_mul_f32 v125, v125, v28
    v_mul_f32 v126, v126, v28
    v_mul_f32 v127, v127, v28
attn_kernel_noscale:
    v_mov_b32 v24, v27
    v_mul_f32 v26, s35, v27
    v_fma_f32 v128, v128, s35, -v26
    v_exp_f32 v128, v128
    v_fma_f32 v129, v129, s35, -v26
    v_exp_f32 v129, v129
    v_fma_f32 v130, v130, s35, -v26
    v_exp_f32 v130, v130
    v_fma_f32 v131, v131, s35, -v26
    v_exp_f32 v131, v131
    v_fma_f32 v132, v132, s35, -v26
    v_exp_f32 v132, v132
    v_fma_f32 v133, v133, s35, -v26
    v_exp_f32 v133, v133
    v_fma_f32 v134, v134, s35, -v26
    v_exp_f32 v134, v134
    v_fma_f32 v135, v135, s35, -v26
    v_exp_f32 v135, v135
    v_fma_f32 v136, v136, s35, -v26
    v_exp_f32 v136, v136
    v_fma_f32 v137, v137, s35, -v26
    v_exp_f32 v137, v137
    v_fma_f32 v138, v138, s35, -v26
    v_exp_f32 v138, v138
    v_fma_f32 v139, v139, s35, -v26
    v_exp_f32 v139, v139
    v_fma_f32 v140, v140, s35, -v26
    v_exp_f32 v140, v140
    v_fma_f32 v141, v141, s35, -v26
    v_exp_f32 v141, v141
    v_fma_f32 v142, v142, s35, -v26
    v_exp_f32 v142, v142
    v_fma_f32 v143, v143, s35, -v26
    v_exp_f32 v143, v143
    s_nop 0
    v_add_f32 v25, v25, v128
    v_add_f32 v25, v25, v129
    v_add_f32 v25, v25, v130
    v_add_f32 v25, v25, v131
    v_add_f32 v25, v25, v132
    v_add_f32 v25, v25, v133
    v_add_f32 v25, v25, v134
    v_add_f32 v25, v25, v135
    v_add_f32 v25, v25, v136
    v_add_f32 v25, v25, v137
    v_add_f32 v25, v25, v138
    v_add_f32 v25, v25, v139
    v_add_f32 v25, v25, v140
    v_add_f32 v25, v25, v141
    v_add_f32 v25, v25, v142
    v_add_f32 v25, v25, v143
    v_cvt_pk_bf16_f32 v144, v128, v129
    v_cvt_pk_bf16_f32 v145, v130, v131
    v_cvt_pk_bf16_f32 v146, v132, v133
    v_cvt_pk_bf16_f32 v147, v134, v135
    v_cvt_pk_bf16_f32 v148, v136, v137
    v_cvt_pk_bf16_f32 v149, v138, v139
    v_cvt_pk_bf16_f32 v150, v140, v141
    v_cvt_pk_bf16_f32 v151, v142, v143
    s_waitcnt lgkmcnt(0)
    s_nop 0
    v_mfma_f32_32x32x16_bf16 v[64:79], v[184:187], v[144:147], v[64:79]
    v_mfma_f32_32x32x16_bf16 v[80:95], v[188:191], v[144:147], v[80:95]
    v_mfma_f32_32x32x16_bf16 v[96:111], v[192:195], v[144:147], v[96:111]
    v_mfma_f32_32x32x16_bf16 v[112:127], v[196:199], v[144:147], v[112:127]
    v_mfma_f32_32x32x16_bf16 v[64:79], v[200:203], v[148:151], v[64:79]
    v_mfma_f32_32x32x16_bf16 v[80:95], v[204:207], v[148:151], v[80:95]
    v_mfma_f32_32x32x16_bf16 v[96:111], v[208:211], v[148:151], v[96:111]
    v_mfma_f32_32x32x16_bf16 v[112:127], v[212:215], v[148:151], v[112:127]
    s_add_u32 s34, s34, 32768
    s_cmp_ge_u32 s34, 131072
    s_mov_b32 s36, 32768
    s_cselect_b32 s36, -98304, s36
    s_cselect_b32 s34, 0, s34
    v_add_u32 v8, s36, v8
    v_add_u32 v9, s36, v9
    v_add_u32 v10, s36, v10
    v_add_u32 v11, s36, v11
    v_add_u32 v12, s36, v12
    v_add_u32 v13, s36, v13
    v_add_u32 v14, s36, v14
    v_add_u32 v15, s36, v15
    v_add_u32 v16, s36, v16
    v_add_u32 v17, s36, v17
    v_add_u32 v18, s36, v18
    v_add_u32 v19, s36, v19
    v_add_u32 v20, s36, v20
    v_add_u32 v21, s36, v21
    v_add_u32 v22, s36, v22
    v_add_u32 v23, s36, v23
    s_add_u32 s32, s32, 1
    s_cmp_lt_u32 s32, 16
    s_cbranch_scc1 attn_kernel_loop
    s_nop 15
    v_mov_b32 v28, v25
    s_nop 1
    v_permlane32_swap_b32 v25, v28
    v_add_f32 v25, v25, v28
    s_waitcnt vmcnt(0) lgkmcnt(0)
    s_barrier
    v_lshlrev_b32 v2, 4, v1
    s_lshl_b32 s3, s25, 14
    v_add_u32 v2, s3, v2
    v_lshlrev_b32 v3, 3, v1
    s_lshl_b32 s3, s25, 9
    v_add_u32 v3, s3, v3
    v_add_u32 v3, 0x10000, v3
    s_cmp_eq_u32 s26, 0
    s_cbranch_scc1 attn_kernel_m0
    ds_write_b128 v2, v[64:67] offset:0
    ds_write_b128 v2, v[68:71] offset:1024
    ds_write_b128 v2, v[72:75] offset:2048
    ds_write_b128 v2, v[76:79] offset:3072
    ds_write_b128 v2, v[80:83] offset:4096
    ds_write_b128 v2, v[84:87] offset:5120
    ds_write_b128 v2, v[88:91] offset:6144
    ds_write_b128 v2, v[92:95] offset:7168
    ds_write_b128 v2, v[96:99] offset:8192
    ds_write_b128 v2, v[100:103] offset:9216
    ds_write_b128 v2, v[104:107] offset:10240
    ds_write_b128 v2, v[108:111] offset:11264
    ds_write_b128 v2, v[112:115] offset:12288
    ds_write_b128 v2, v[116:119] offset:13312
    ds_write_b128 v2, v[120:123] offset:14336
    ds_write_b128 v2, v[124:127] offset:15360
    ds_write_b64 v3, v[24:25]
    s_waitcnt lgkmcnt(0)
    s_barrier
    s_branch attn_kernel_done
attn_kernel_m0:
    s_barrier
    ds_read_b128 v[128:131], v2 offset:0
    ds_read_b128 v[132:135], v2 offset:1024
    ds_read_b128 v[136:139], v2 offset:2048
    ds_read_b128 v[140:143], v2 offset:3072
    ds_read_b128 v[144:147], v2 offset:4096
    ds_read_b128 v[148:151], v2 offset:5120
    ds_read_b128 v[152:155], v2 offset:6144
    ds_read_b128 v[156:159], v2 offset:7168
    ds_read_b128 v[160:163], v2 offset:8192
    ds_read_b128 v[164:167], v2 offset:9216
    ds_read_b128 v[168:171], v2 offset:10240
    ds_read_b128 v[172:175], v2 offset:11264
    ds_read_b128 v[176:179], v2 offset:12288
    ds_read_b128 v[180:183], v2 offset:13312
    ds_read_b128 v[184:187], v2 offset:14336
    ds_read_b128 v[188:191], v2 offset:15360
    ds_read_b64 v[26:27], v3
    s_waitcnt lgkmcnt(0)
    v_max_f32 v28, v24, v26
    v_sub_f32 v29, v24, v28
    v_sub_f32 v30, v26, v28
    v_mul_f32 v29, s35, v29
    v_mul_f32 v30, s35, v30
    v_exp_f32 v29, v29
    v_exp_f32 v30, v30
    s_nop 0
    v_mul_f32 v25, v25, v29
    v_fmac_f32 v25, v27, v30
    v_rcp_f32 v25, v25
    s_nop 0
    v_mul_f32 v29, v29, v25
    v_mul_f32 v30, v30, v25
    v_mul_f32 v64, v64, v29
    v_fmac_f32 v64, v128, v30
    v_mul_f32 v65, v65, v29
    v_fmac_f32 v65, v129, v30
    v_mul_f32 v66, v66, v29
    v_fmac_f32 v66, v130, v30
    v_mul_f32 v67, v67, v29
    v_fmac_f32 v67, v131, v30
    v_mul_f32 v68, v68, v29
    v_fmac_f32 v68, v132, v30
    v_mul_f32 v69, v69, v29
    v_fmac_f32 v69, v133, v30
    v_mul_f32 v70, v70, v29
    v_fmac_f32 v70, v134, v30
    v_mul_f32 v71, v71, v29
    v_fmac_f32 v71, v135, v30
    v_mul_f32 v72, v72, v29
    v_fmac_f32 v72, v136, v30
    v_mul_f32 v73, v73, v29
    v_fmac_f32 v73, v137, v30
    v_mul_f32 v74, v74, v29
    v_fmac_f32 v74, v138, v30
    v_mul_f32 v75, v75, v29
    v_fmac_f32 v75, v139, v30
    v_mul_f32 v76, v76, v29
    v_fmac_f32 v76, v140, v30
    v_mul_f32 v77, v77, v29
    v_fmac_f32 v77, v141, v30
    v_mul_f32 v78, v78, v29
    v_fmac_f32 v78, v142, v30
    v_mul_f32 v79, v79, v29
    v_fmac_f32 v79, v143, v30
    v_mul_f32 v80, v80, v29
    v_fmac_f32 v80, v144, v30
    v_mul_f32 v81, v81, v29
    v_fmac_f32 v81, v145, v30
    v_mul_f32 v82, v82, v29
    v_fmac_f32 v82, v146, v30
    v_mul_f32 v83, v83, v29
    v_fmac_f32 v83, v147, v30
    v_mul_f32 v84, v84, v29
    v_fmac_f32 v84, v148, v30
    v_mul_f32 v85, v85, v29
    v_fmac_f32 v85, v149, v30
    v_mul_f32 v86, v86, v29
    v_fmac_f32 v86, v150, v30
    v_mul_f32 v87, v87, v29
    v_fmac_f32 v87, v151, v30
    v_mul_f32 v88, v88, v29
    v_fmac_f32 v88, v152, v30
    v_mul_f32 v89, v89, v29
    v_fmac_f32 v89, v153, v30
    v_mul_f32 v90, v90, v29
    v_fmac_f32 v90, v154, v30
    v_mul_f32 v91, v91, v29
    v_fmac_f32 v91, v155, v30
    v_mul_f32 v92, v92, v29
    v_fmac_f32 v92, v156, v30
    v_mul_f32 v93, v93, v29
    v_fmac_f32 v93, v157, v30
    v_mul_f32 v94, v94, v29
    v_fmac_f32 v94, v158, v30
    v_mul_f32 v95, v95, v29
    v_fmac_f32 v95, v159, v30
    v_mul_f32 v96, v96, v29
    v_fmac_f32 v96, v160, v30
    v_mul_f32 v97, v97, v29
    v_fmac_f32 v97, v161, v30
    v_mul_f32 v98, v98, v29
    v_fmac_f32 v98, v162, v30
    v_mul_f32 v99, v99, v29
    v_fmac_f32 v99, v163, v30
    v_mul_f32 v100, v100, v29
    v_fmac_f32 v100, v164, v30
    v_mul_f32 v101, v101, v29
    v_fmac_f32 v101, v165, v30
    v_mul_f32 v102, v102, v29
    v_fmac_f32 v102, v166, v30
    v_mul_f32 v103, v103, v29
    v_fmac_f32 v103, v167, v30
    v_mul_f32 v104, v104, v29
    v_fmac_f32 v104, v168, v30
    v_mul_f32 v105, v105, v29
    v_fmac_f32 v105, v169, v30
    v_mul_f32 v106, v106, v29
    v_fmac_f32 v106, v170, v30
    v_mul_f32 v107, v107, v29
    v_fmac_f32 v107, v171, v30
    v_mul_f32 v108, v108, v29
    v_fmac_f32 v108, v172, v30
    v_mul_f32 v109, v109, v29
    v_fmac_f32 v109, v173, v30
    v_mul_f32 v110, v110, v29
    v_fmac_f32 v110, v174, v30
    v_mul_f32 v111, v111, v29
    v_fmac_f32 v111, v175, v30
    v_mul_f32 v112, v112, v29
    v_fmac_f32 v112, v176, v30
    v_mul_f32 v113, v113, v29
    v_fmac_f32 v113, v177, v30
    v_mul_f32 v114, v114, v29
    v_fmac_f32 v114, v178, v30
    v_mul_f32 v115, v115, v29
    v_fmac_f32 v115, v179, v30
    v_mul_f32 v116, v116, v29
    v_fmac_f32 v116, v180, v30
    v_mul_f32 v117, v117, v29
    v_fmac_f32 v117, v181, v30
    v_mul_f32 v118, v118, v29
    v_fmac_f32 v118, v182, v30
    v_mul_f32 v119, v119, v29
    v_fmac_f32 v119, v183, v30
    v_mul_f32 v120, v120, v29
    v_fmac_f32 v120, v184, v30
    v_mul_f32 v121, v121, v29
    v_fmac_f32 v121, v185, v30
    v_mul_f32 v122, v122, v29
    v_fmac_f32 v122, v186, v30
    v_mul_f32 v123, v123, v29
    v_fmac_f32 v123, v187, v30
    v_mul_f32 v124, v124, v29
    v_fmac_f32 v124, v188, v30
    v_mul_f32 v125, v125, v29
    v_fmac_f32 v125, v189, v30
    v_mul_f32 v126, v126, v29
    v_fmac_f32 v126, v190, v30
    v_mul_f32 v127, v127, v29
    v_fmac_f32 v127, v191, v30
    s_lshl_b32 s3, s2, 15
    s_add_u32 s3, s3, 8388608
    s_add_u32 s20, s20, s3
    s_addc_u32 s21, s21, 0
    s_mov_b32 s12, s20
    s_and_b32 s13, s21, 0xffff
    s_mov_b32 s14, 32768
    s_mov_b32 s15, 0x00020000
    s_lshl_b32 s3, s25, 13
    v_lshlrev_b32 v4, 4, v1
    v_add_u32 v4, s3, v4
    v_cvt_pk_bf16_f32 v152, v64, v65
    v_cvt_pk_bf16_f32 v153, v66, v67
    v_cvt_pk_bf16_f32 v154, v68, v69
    v_cvt_pk_bf16_f32 v155, v70, v71
    s_nop 1
    v_permlane32_swap_b32 v152, v154
    v_permlane32_swap_b32 v153, v155
    s_mov_b32 s29, 0
    buffer_store_dwordx4 v[152:155], v4, s[12:15], s29 offen
    s_nop 1
    v_cvt_pk_bf16_f32 v156, v72, v73
    v_cvt_pk_bf16_f32 v157, v74, v75
    v_cvt_pk_bf16_f32 v158, v76, v77
    v_cvt_pk_bf16_f32 v159, v78, v79
    s_nop 1
    v_permlane32_swap_b32 v156, v158
    v_permlane32_swap_b32 v157, v159
    s_mov_b32 s29, 1024
    buffer_store_dwordx4 v[156:159], v4, s[12:15], s29 offen
    s_nop 1
    v_cvt_pk_bf16_f32 v152, v80, v81
    v_cvt_pk_bf16_f32 v153, v82, v83
    v_cvt_pk_bf16_f32 v154, v84, v85
    v_cvt_pk_bf16_f32 v155, v86, v87
    s_nop 1
    v_permlane32_swap_b32 v152, v154
    v_permlane32_swap_b32 v153, v155
    s_mov_b32 s29, 2048
    buffer_store_dwordx4 v[152:155], v4, s[12:15], s29 offen
    s_nop 1
    v_cvt_pk_bf16_f32 v156, v88, v89
    v_cvt_pk_bf16_f32 v157, v90, v91
    v_cvt_pk_bf16_f32 v158, v92, v93
    v_cvt_pk_bf16_f32 v159, v94, v95
    s_nop 1
    v_permlane32_swap_b32 v156, v158
    v_permlane32_swap_b32 v157, v159
    s_mov_b32 s29, 3072
    buffer_store_dwordx4 v[156:159], v4, s[12:15], s29 offen
    s_nop 1
    v_cvt_pk_bf16_f32 v152, v96, v97
    v_cvt_pk_bf16_f32 v153, v98, v99
    v_cvt_pk_bf16_f32 v154, v100, v101
    v_cvt_pk_bf16_f32 v155, v102, v103
    s_nop 1
    v_permlane32_swap_b32 v152, v154
    v_permlane32_swap_b32 v153, v155
    s_mov_b32 s29, 4096
    buffer_store_dwordx4 v[152:155], v4, s[12:15], s29 offen
    s_nop 1
    v_cvt_pk_bf16_f32 v156, v104, v105
    v_cvt_pk_bf16_f32 v157, v106, v107
    v_cvt_pk_bf16_f32 v158, v108, v109
    v_cvt_pk_bf16_f32 v159, v110, v111
    s_nop 1
    v_permlane32_swap_b32 v156, v158
    v_permlane32_swap_b32 v157, v159
    s_mov_b32 s29, 5120
    buffer_store_dwordx4 v[156:159], v4, s[12:15], s29 offen
    s_nop 1
    v_cvt_pk_bf16_f32 v152, v112, v113
    v_cvt_pk_bf16_f32 v153, v114, v115
    v_cvt_pk_bf16_f32 v154, v116, v117
    v_cvt_pk_bf16_f32 v155, v118, v119
    s_nop 1
    v_permlane32_swap_b32 v152, v154
    v_permlane32_swap_b32 v153, v155
    s_mov_b32 s29, 6144
    buffer_store_dwordx4 v[152:155], v4, s[12:15], s29 offen
    s_nop 1
    v_cvt_pk_bf16_f32 v156, v120, v121
    v_cvt_pk_bf16_f32 v157, v122, v123
    v_cvt_pk_bf16_f32 v158, v124, v125
    v_cvt_pk_bf16_f32 v159, v126, v127
    s_nop 1
    v_permlane32_swap_b32 v156, v158
    v_permlane32_swap_b32 v157, v159
    s_mov_b32 s29, 7168
    buffer_store_dwordx4 v[156:159], v4, s[12:15], s29 offen
    s_nop 1
attn_kernel_done:
    s_endpgm
.section .rodata,"a"
.p2align 6
.amdhsa_kernel attn_kernel
  .amdhsa_next_free_vgpr 216
  .amdhsa_next_free_sgpr 40
  .amdhsa_accum_offset 216
  .amdhsa_group_segment_fixed_size 0
  .amdhsa_kernarg_size 64
  .amdhsa_user_sgpr_count 2
  .amdhsa_user_sgpr_kernarg_segment_ptr 1
  .amdhsa_system_sgpr_workgroup_id_x 1
.end_amdhsa_kernel
.text
.p2align 8
oproj_kernel:
    s_cmp_ge_u32 s2, 256
    s_cbranch_scc1 oproj_kernel_done
    s_load_dwordx2 s[18:19], s[0:1], 32
    s_load_dwordx2 s[20:21], s[0:1], 56
    s_lshr_b32 s22, s2, 5
    v_and_b32 v1, 63, v0
    v_lshrrev_b32 v2, 6, v0
    s_nop 0
    v_readfirstlane_b32 s24, v2
    s_waitcnt lgkmcnt(0)
    s_bfe_u32 s23, s2, 0x20003
    s_and_b32 s28, s2, 7
    s_lshl_b32 s3, s22, 3
    s_add_u32 s3, s3, s28
    s_lshl_b32 s3, s3, 17
    s_add_u32 s3, s3, 8388608
    s_mov_b32 s16, s20
    s_mov_b32 s17, s21
    s_add_u32 s16, s16, s3
    s_addc_u32 s17, s17, 0
    s_mov_b32 s4, s16
    s_and_b32 s5, s17, 0xffff
    s_mov_b32 s6, 131072
    s_mov_b32 s7, 0x00020000
    s_lshl_b32 s3, s28, 19
    s_lshl_b32 s29, s23, 8
    s_add_u32 s3, s3, s29
    s_add_u32 s18, s18, s3
    s_addc_u32 s19, s19, 0
    s_sub_u32 s25, 4194304, s3
    s_mov_b32 s8, s18
    s_and_b32 s9, s19, 0xffff
    s_mov_b32 s10, s25
    s_mov_b32 s11, 0x00020000
    s_lshl_b32 s3, s2, 16
    s_add_u32 s3, s3, 16777216
    s_add_u32 s20, s20, s3
    s_addc_u32 s21, s21, 0
    s_mov_b32 s12, s20
    s_and_b32 s13, s21, 0xffff
    s_mov_b32 s14, 65536
    s_mov_b32 s15, 0x00020000
    s_lshl_b32 s26, s23, 9
    s_lshl_b32 s27, s28, 10
    v_lshrrev_b32 v2, 4, v1
    v_and_b32 v3, 15, v1
    s_lshl_b32 s3, s24, 4
    v_add_u32 v4, 0, v2
    v_add_u32 v4, s3, v4
    v_mul_u32_u24 v4, 1024, v4
    v_lshlrev_b32 v5, 2, v2
    v_or_b32 v5, 0, v5
    v_xor_b32 v5, v5, v3
    v_lshlrev_b32 v5, 4, v5
    v_add_u32 v6, v4, v5
    v_add_u32 v4, 4, v2
    v_add_u32 v4, s3, v4
    v_mul_u32_u24 v4, 1024, v4
    v_lshlrev_b32 v5, 2, v2
    v_or_b32 v5, 1, v5
    v_xor_b32 v5, v5, v3
    v_lshlrev_b32 v5, 4, v5
    v_add_u32 v7, v4, v5
    v_add_u32 v4, 8, v2
    v_add_u32 v4, s3, v4
    v_mul_u32_u24 v4, 1024, v4
    v_lshlrev_b32 v5, 2, v2
    v_or_b32 v5, 2, v5
    v_xor_b32 v5, v5, v3
    v_lshlrev_b32 v5, 4, v5
    v_add_u32 v8, v4, v5
    v_add_u32 v4, 12, v2
    v_add_u32 v4, s3, v4
    v_mul_u32_u24 v4, 1024, v4
    v_lshlrev_b32 v5, 2, v2
    v_or_b32 v5, 3, v5
    v_xor_b32 v5, v5, v3
    v_lshlrev_b32 v5, 4, v5
    v_add_u32 v9, v4, v5
    s_and_b32 s3, s24, 3
    s_lshl_b32 s3, s3, 5
    v_and_b32 v4, 31, v1
    v_add_u32 v4, s3, v4
    v_mul_u32_u24 v10, 8192, v4
    v_lshrrev_b32 v5, 5, v1
    v_lshlrev_b32 v11, 4, v5
    v_add_u32 v10, v10, v11
    v_add_u32 v10, s27, v10
    s_and_b32 s3, s24, 3
    s_lshl_b32 s3, s3, 13
    v_lshlrev_b32 v10, 4, v1
    v_add_u32 v10, s3, v10
    s_lshl_b32 s30, s24, 12
    s_mov_b32 s29, 0
    buffer_load_dwordx4 v[32:35], v10, s[4:7], s29 offen
    s_mov_b32 s29, 1024
    buffer_load_dwordx4 v[36:39], v10, s[4:7], s29 offen
    s_mov_b32 s29, 2048
    buffer_load_dwordx4 v[40:43], v10, s[4:7], s29 offen
    s_mov_b32 s29, 3072
    buffer_load_dwordx4 v[44:47], v10, s[4:7], s29 offen
    s_mov_b32 s29, 4096
    buffer_load_dwordx4 v[48:51], v10, s[4:7], s29 offen
    s_mov_b32 s29, 5120
    buffer_load_dwordx4 v[52:55], v10, s[4:7], s29 offen
    s_mov_b32 s29, 6144
    buffer_load_dwordx4 v[56:59], v10, s[4:7], s29 offen
    s_mov_b32 s29, 7168
    buffer_load_dwordx4 v[60:63], v10, s[4:7], s29 offen
    s_mov_b32 s31, 0
    s_add_u32 m0, s30, 0
    s_nop 0
    buffer_load_dwordx4 v6, s[8:11], s31 offen lds
    s_add_u32 m0, s30, 1024
    s_nop 0
    buffer_load_dwordx4 v7, s[8:11], s31 offen lds
    s_add_u32 m0, s30, 2048
    s_nop 0
    buffer_load_dwordx4 v8, s[8:11], s31 offen lds
    s_add_u32 m0, s30, 3072
    s_nop 0
    buffer_load_dwordx4 v9, s[8:11], s31 offen lds
    s_mov_b32 s29, 32768
    buffer_load_dwordx4 v[64:67], v10, s[4:7], s29 offen
    s_mov_b32 s29, 33792
    buffer_load_dwordx4 v[68:71], v10, s[4:7], s29 offen
    s_mov_b32 s29, 34816
    buffer_load_dwordx4 v[72:75], v10, s[4:7], s29 offen
    s_mov_b32 s29, 35840
    buffer_load_dwordx4 v[76:79], v10, s[4:7], s29 offen
    s_mov_b32 s29, 36864
    buffer_load_dwordx4 v[80:83], v10, s[4:7], s29 offen
    s_mov_b32 s29, 37888
    buffer_load_dwordx4 v[84:87], v10, s[4:7], s29 offen
    s_mov_b32 s29, 38912
    buffer_load_dwordx4 v[88:91], v10, s[4:7], s29 offen
    s_mov_b32 s29, 39936
    buffer_load_dwordx4 v[92:95], v10, s[4:7], s29 offen
    s_mov_b32 s31, 131072
    s_add_u32 m0, s30, 32768
    s_nop 0
    buffer_load_dwordx4 v6, s[8:11], s31 offen lds
    s_add_u32 m0, s30, 33792
    s_nop 0
    buffer_load_dwordx4 v7, s[8:11], s31 offen lds
    s_add_u32 m0, s30, 34816
    s_nop 0
    buffer_load_dwordx4 v8, s[8:11], s31 offen lds
    s_add_u32 m0, s30, 35840
    s_nop 0
    buffer_load_dwordx4 v9, s[8:11], s31 offen lds
    s_mov_b32 s29, 65536
    buffer_load_dwordx4 v[96:99], v10, s[4:7], s29 offen
    s_mov_b32 s29, 66560
    buffer_load_dwordx4 v[100:103], v10, s[4:7], s29 offen
    s_mov_b32 s29, 67584
    buffer_load_dwordx4 v[104:107], v10, s[4:7], s29 offen
    s_mov_b32 s29, 68608
    buffer_load_dwordx4 v[108:111], v10, s[4:7], s29 offen
    s_mov_b32 s29, 69632
    buffer_load_dwordx4 v[112:115], v10, s[4:7], s29 offen
    s_mov_b32 s29, 70656
    buffer_load_dwordx4 v[116:119], v10, s[4:7], s29 offen
    s_mov_b32 s29, 71680
    buffer_load_dwordx4 v[120:123], v10, s[4:7], s29 offen
    s_mov_b32 s29, 72704
    buffer_load_dwordx4 v[124:127], v10, s[4:7], s29 offen
    s_mov_b32 s31, 262144
    s_add_u32 m0, s30, 65536
    s_nop 0
    buffer_load_dwordx4 v6, s[8:11], s31 offen lds
    s_add_u32 m0, s30, 66560
    s_nop 0
    buffer_load_dwordx4 v7, s[8:11], s31 offen lds
    s_add_u32 m0, s30, 67584
    s_nop 0
    buffer_load_dwordx4 v8, s[8:11], s31 offen lds
    s_add_u32 m0, s30, 68608
    s_nop 0
    buffer_load_dwordx4 v9, s[8:11], s31 offen lds
    s_mov_b32 s29, 98304
    buffer_load_dwordx4 v[128:131], v10, s[4:7], s29 offen
    s_mov_b32 s29, 99328
    buffer_load_dwordx4 v[132:135], v10, s[4:7], s29 offen
    s_mov_b32 s29, 100352
    buffer_load_dwordx4 v[136:139], v10, s[4:7], s29 offen
    s_mov_b32 s29, 101376
    buffer_load_dwordx4 v[140:143], v10, s[4:7], s29 offen
    s_mov_b32 s29, 102400
    buffer_load_dwordx4 v[144:147], v10, s[4:7], s29 offen
    s_mov_b32 s29, 103424
    buffer_load_dwordx4 v[148:151], v10, s[4:7], s29 offen
    s_mov_b32 s29, 104448
    buffer_load_dwordx4 v[152:155], v10, s[4:7], s29 offen
    s_mov_b32 s29, 105472
    buffer_load_dwordx4 v[156:159], v10, s[4:7], s29 offen
    s_mov_b32 s31, 393216
    s_add_u32 m0, s30, 98304
    s_nop 0
    buffer_load_dwordx4 v6, s[8:11], s31 offen lds
    s_add_u32 m0, s30, 99328
    s_nop 0
    buffer_load_dwordx4 v7, s[8:11], s31 offen lds
    s_add_u32 m0, s30, 100352
    s_nop 0
    buffer_load_dwordx4 v8, s[8:11], s31 offen lds
    s_add_u32 m0, s30, 101376
    s_nop 0
    buffer_load_dwordx4 v9, s[8:11], s31 offen lds
    v_and_b32 v2, 15, v1
    v_bfe_u32 v3, v1, 4, 1
    v_lshrrev_b32 v5, 5, v1
    s_lshr_b32 s3, s24, 2
    s_lshl_b32 s3, s3, 3
    v_lshrrev_b32 v20, 2, v2
    v_lshl_add_u32 v21, v5, 3, v20
    v_add_u32 v21, 0, v21
    v_bfe_u32 v22, v2, 1, 1
    v_lshl_add_u32 v22, v3, 1, v22
    v_add_u32 v22, 0, v22
    v_add_u32 v22, s3, v22
    v_lshlrev_b32 v23, 2, v20
    v_lshl_add_u32 v23, v5, 1, v23
    v_add_u32 v23, 0, v23
    v_xor_b32 v22, v22, v23
    v_lshlrev_b32 v22, 4, v22
    v_lshl_add_u32 v22, v21, 8, v22
    v_and_b32 v23, 1, v2
    v_lshl_add_u32 v12, v23, 3, v22
    v_lshrrev_b32 v20, 2, v2
    v_lshl_add_u32 v21, v5, 3, v20
    v_add_u32 v21, 4, v21
    v_bfe_u32 v22, v2, 1, 1
    v_lshl_add_u32 v22, v3, 1, v22
    v_add_u32 v22, 0, v22
    v_add_u32 v22, s3, v22
    v_lshlrev_b32 v23, 2, v20
    v_lshl_add_u32 v23, v5, 1, v23
    v_add_u32 v23, 1, v23
    v_xor_b32 v22, v22, v23
    v_lshlrev_b32 v22, 4, v22
    v_lshl_add_u32 v22, v21, 8, v22
    v_and_b32 v23, 1, v2
    v_lshl_add_u32 v13, v23, 3, v22
    v_lshrrev_b32 v20, 2, v2
    v_lshl_add_u32 v21, v5, 3, v20
    v_add_u32 v21, 0, v21
    v_bfe_u32 v22, v2, 1, 1
    v_lshl_add_u32 v22, v3, 1, v22
    v_add_u32 v22, 4, v22
    v_add_u32 v22, s3, v22
    v_lshlrev_b32 v23, 2, v20
    v_lshl_add_u32 v23, v5, 1, v23
    v_add_u32 v23, 0, v23
    v_xor_b32 v22, v22, v23
    v_lshlrev_b32 v22, 4, v22
    v_lshl_add_u32 v22, v21, 8, v22
    v_and_b32 v23, 1, v2
    v_lshl_add_u32 v14, v23, 3, v22
    v_lshrrev_b32 v20, 2, v2
    v_lshl_add_u32 v21, v5, 3, v20
    v_add_u32 v21, 4, v21
    v_bfe_u32 v22, v2, 1, 1
    v_lshl_add_u32 v22, v3, 1, v22
    v_add_u32 v22, 4, v22
    v_add_u32 v22, s3, v22
    v_lshlrev_b32 v23, 2, v20
    v_lshl_add_u32 v23, v5, 1, v23
    v_add_u32 v23, 1, v23
    v_xor_b32 v22, v22, v23
    v_lshlrev_b32 v22, 4, v22
    v_lshl_add_u32 v22, v21, 8, v22
    v_and_b32 v23, 1, v2
    v_lshl_add_u32 v15, v23, 3, v22
    v_add_u32 v16, 0x10000, v12
    v_add_u32 v17, 0x10000, v13
    v_add_u32 v18, 0x10000, v14
    v_add_u32 v19, 0x10000, v15
    s_waitcnt vmcnt(0)
    s_barrier
    ds_read_b64_tr_b16 v[192:193], v12 offset:0
    ds_read_b64_tr_b16 v[194:195], v13 offset:0
    ds_read_b64_tr_b16 v[196:197], v14 offset:0
    ds_read_b64_tr_b16 v[198:199], v15 offset:0
    ds_read_b64_tr_b16 v[200:201], v12 offset:4096
    ds_read_b64_tr_b16 v[202:203], v13 offset:4096
    ds_read_b64_tr_b16 v[204:205], v14 offset:4096
    ds_read_b64_tr_b16 v[206:207], v15 offset:4096
    s_waitcnt lgkmcnt(4)
    v_mfma_f32_32x32x16_bf16 v[160:175], v[192:195], v[32:35], 0
    v_mfma_f32_32x32x16_bf16 v[176:191], v[196:199], v[32:35], 0
    ds_read_b64_tr_b16 v[192:193], v12 offset:8192
    ds_read_b64_tr_b16 v[194:195], v13 offset:8192
    ds_read_b64_tr_b16 v[196:197], v14 offset:8192
    ds_read_b64_tr_b16 v[198:199], v15 offset:8192
    s_waitcnt lgkmcnt(4)
    v_mfma_f32_32x32x16_bf16 v[160:175], v[200:203], v[36:39], v[160:175]
    v_mfma_f32_32x32x16_bf16 v[176:191], v[204:207], v[36:39], v[176:191]
    ds_read_b64_tr_b16 v[200:201], v12 offset:12288
    ds_read_b64_tr_b16 v[202:203], v13 offset:12288
    ds_read_b64_tr_b16 v[204:205], v14 offset:12288
    ds_read_b64_tr_b16 v[206:207], v15 offset:12288
    s_waitcnt lgkmcnt(4)
    v_mfma_f32_32x32x16_bf16 v[160:175], v[192:195], v[40:43], v[160:175]
    v_mfma_f32_32x32x16_bf16 v[176:191], v[196:199], v[40:43], v[176:191]
    ds_read_b64_tr_b16 v[192:193], v12 offset:16384
    ds_read_b64_tr_b16 v[194:195], v13 offset:16384
    ds_read_b64_tr_b16 v[196:197], v14 offset:16384
    ds_read_b64_tr_b16 v[198:199], v15 offset:16384
    s_waitcnt lgkmcnt(4)
    v_mfma_f32_32x32x16_bf16 v[160:175], v[200:203], v[44:47], v[160:175]
    v_mfma_f32_32x32x16_bf16 v[176:191], v[204:207], v[44:47], v[176:191]
    ds_read_b64_tr_b16 v[200:201], v12 offset:20480
    ds_read_b64_tr_b16 v[202:203], v13 offset:20480
    ds_read_b64_tr_b16 v[204:205], v14 offset:20480
    ds_read_b64_tr_b16 v[206:207], v15 offset:20480
    s_waitcnt lgkmcnt(4)
    v_mfma_f32_32x32x16_bf16 v[160:175], v[192:195], v[48:51], v[160:175]
    v_mfma_f32_32x32x16_bf16 v[176:191], v[196:199], v[48:51], v[176:191]
    ds_read_b64_tr_b16 v[192:193], v12 offset:24576
    ds_read_b64_tr_b16 v[194:195], v13 offset:24576
    ds_read_b64_tr_b16 v[196:197], v14 offset:24576
    ds_read_b64_tr_b16 v[198:199], v15 offset:24576
    s_waitcnt lgkmcnt(4)
    v_mfma_f32_32x32x16_bf16 v[160:175], v[200:203], v[52:55], v[160:175]
    v_mfma_f32_32x32x16_bf16 v[176:191], v[204:207], v[52:55], v[176:191]
    ds_read_b64_tr_b16 v[200:201], v12 offset:28672
    ds_read_b64_tr_b16 v[202:203], v13 offset:28672
    ds_read_b64_tr_b16 v[204:205], v14 offset:28672
    ds_read_b64_tr_b16 v[206:207], v15 offset:28672
    s_waitcnt lgkmcnt(4)
    v_mfma_f32_32x32x16_bf16 v[160:175], v[192:195], v[56:59], v[160:175]
    v_mfma_f32_32x32x16_bf16 v[176:191], v[196:199], v[56:59], v[176:191]
    ds_read_b64_tr_b16 v[192:193], v12 offset:32768
    ds_read_b64_tr_b16 v[194:195], v13 offset:32768
    ds_read_b64_tr_b16 v[196:197], v14 offset:32768
    ds_read_b64_tr_b16 v[198:199], v15 offset:32768
    s_waitcnt lgkmcnt(4)
    v_mfma_f32_32x32x16_bf16 v[160:175], v[200:203], v[60:63], v[160:175]
    v_mfma_f32_32x32x16_bf16 v[176:191], v[204:207], v[60:63], v[176:191]
    ds_read_b64_tr_b16 v[200:201], v12 offset:36864
    ds_read_b64_tr_b16 v[202:203], v13 offset:36864
    ds_read_b64_tr_b16 v[204:205], v14 offset:36864
    ds_read_b64_tr_b16 v[206:207], v15 offset:36864
    s_waitcnt lgkmcnt(4)
    v_mfma_f32_32x32x16_bf16 v[160:175], v[192:195], v[64:67], v[160:175]
    v_mfma_f32_32x32x16_bf16 v[176:191], v[196:199], v[64:67], v[176:191]
    ds_read_b64_tr_b16 v[192:193], v12 offset:40960
    ds_read_b64_tr_b16 v[194:195], v13 offset:40960
    ds_read_b64_tr_b16 v[196:197], v14 offset:40960
    ds_read_b64_tr_b16 v[198:199], v15 offset:40960
    s_waitcnt lgkmcnt(4)
    v_mfma_f32_32x32x16_bf16 v[160:175], v[200:203], v[68:71], v[160:175]
    v_mfma_f32_32x32x16_bf16 v[176:191], v[204:207], v[68:71], v[176:191]
    ds_read_b64_tr_b16 v[200:201], v12 offset:45056
    ds_read_b64_tr_b16 v[202:203], v13 offset:45056
    ds_read_b64_tr_b16 v[204:205], v14 offset:45056
    ds_read_b64_tr_b16 v[206:207], v15 offset:45056
    s_waitcnt lgkmcnt(4)
    v_mfma_f32_32x32x16_bf16 v[160:175], v[192:195], v[72:75], v[160:175]
    v_mfma_f32_32x32x16_bf16 v[176:191], v[196:199], v[72:75], v[176:191]
    ds_read_b64_tr_b16 v[192:193], v12 offset:49152
    ds_read_b64_tr_b16 v[194:195], v13 offset:49152
    ds_read_b64_tr_b16 v[196:197], v14 offset:49152
    ds_read_b64_tr_b16 v[198:199], v15 offset:49152
    s_waitcnt lgkmcnt(4)
    v_mfma_f32_32x32x16_bf16 v[160:175], v[200:203], v[76:79], v[160:175]
    v_mfma_f32_32x32x16_bf16 v[176:191], v[204:207], v[76:79], v[176:191]
    ds_read_b64_tr_b16 v[200:201], v12 offset:53248
    ds_read_b64_tr_b16 v[202:203], v13 offset:53248
    ds_read_b64_tr_b16 v[204:205], v14 offset:53248
    ds_read_b64_tr_b16 v[206:207], v15 offset:53248
    s_waitcnt lgkmcnt(4)
    v_mfma_f32_32x32x16_bf16 v[160:175], v[192:195], v[80:83], v[160:175]
    v_mfma_f32_32x32x16_bf16 v[176:191], v[196:199], v[80:83], v[176:191]
    ds_read_b64_tr_b16 v[192:193], v12 offset:57344
    ds_read_b64_tr_b16 v[194:195], v13 offset:57344
    ds_read_b64_tr_b16 v[196:197], v14 offset:57344
    ds_read_b64_tr_b16 v[198:199], v15 offset:57344
    s_waitcnt lgkmcnt(4)
    v_mfma_f32_32x32x16_bf16 v[160:175], v[200:203], v[84:87], v[160:175]
    v_mfma_f32_32x32x16_bf16 v[176:191], v[204:207], v[84:87], v[176:191]
    ds_read_b64_tr_b16 v[200:201], v12 offset:61440
    ds_read_b64_tr_b16 v[202:203], v13 offset:61440
    ds_read_b64_tr_b16 v[204:205], v14 offset:61440
    ds_read_b64_tr_b16 v[206:207], v15 offset:61440
    s_waitcnt lgkmcnt(4)
    v_mfma_f32_32x32x16_bf16 v[160:175], v[192:195], v[88:91], v[160:175]
    v_mfma_f32_32x32x16_bf16 v[176:191], v[196:199], v[88:91], v[176:191]
    ds_read_b64_tr_b16 v[192:193], v16 offset:0
    ds_read_b64_tr_b16 v[194:195], v17 offset:0
    ds_read_b64_tr_b16 v[196:197], v18 offset:0
    ds_read_b64_tr_b16 v[198:199], v19 offset:0
    s_waitcnt lgkmcnt(4)
    v_mfma_f32_32x32x16_bf16 v[160:175], v[200:203], v[92:95], v[160:175]
    v_mfma_f32_32x32x16_bf16 v[176:191], v[204:207], v[92:95], v[176:191]
    ds_read_b64_tr_b16 v[200:201], v16 offset:4096
    ds_read_b64_tr_b16 v[202:203], v17 offset:4096
    ds_read_b64_tr_b16 v[204:205], v18 offset:4096
    ds_read_b64_tr_b16 v[206:207], v19 offset:4096
    s_waitcnt lgkmcnt(4)
    v_mfma_f32_32x32x16_bf16 v[160:175], v[192:195], v[96:99], v[160:175]
    v_mfma_f32_32x32x16_bf16 v[176:191], v[196:199], v[96:99], v[176:191]
    ds_read_b64_tr_b16 v[192:193], v16 offset:8192
    ds_read_b64_tr_b16 v[194:195], v17 offset:8192
    ds_read_b64_tr_b16 v[196:197], v18 offset:8192
    ds_read_b64_tr_b16 v[198:199], v19 offset:8192
    s_waitcnt lgkmcnt(4)
    v_mfma_f32_32x32x16_bf16 v[160:175], v[200:203], v[100:103], v[160:175]
    v_mfma_f32_32x32x16_bf16 v[176:191], v[204:207], v[100:103], v[176:191]
    ds_read_b64_tr_b16 v[200:201], v16 offset:12288
    ds_read_b64_tr_b16 v[202:203], v17 offset:12288
    ds_read_b64_tr_b16 v[204:205], v18 offset:12288
    ds_read_b64_tr_b16 v[206:207], v19 offset:12288
    s_waitcnt lgkmcnt(4)
    v_mfma_f32_32x32x16_bf16 v[160:175], v[192:195], v[104:107], v[160:175]
    v_mfma_f32_32x32x16_bf16 v[176:191], v[196:199], v[104:107], v[176:191]
    ds_read_b64_tr_b16 v[192:193], v16 offset:16384
    ds_read_b64_tr_b16 v[194:195], v17 offset:16384
    ds_read_b64_tr_b16 v[196:197], v18 offset:16384
    ds_read_b64_tr_b16 v[198:199], v19 offset:16384
    s_waitcnt lgkmcnt(4)
    v_mfma_f32_32x32x16_bf16 v[160:175], v[200:203], v[108:111], v[160:175]
    v_mfma_f32_32x32x16_bf16 v[176:191], v[204:207], v[108:111], v[176:191]
    ds_read_b64_tr_b16 v[200:201], v16 offset:20480
    ds_read_b64_tr_b16 v[202:203], v17 offset:20480
    ds_read_b64_tr_b16 v[204:205], v18 offset:20480
    ds_read_b64_tr_b16 v[206:207], v19 offset:20480
    s_waitcnt lgkmcnt(4)
    v_mfma_f32_32x32x16_bf16 v[160:175], v[192:195], v[112:115], v[160:175]
    v_mfma_f32_32x32x16_bf16 v[176:191], v[196:199], v[112:115], v[176:191]
    ds_read_b64_tr_b16 v[192:193], v16 offset:24576
    ds_read_b64_tr_b16 v[194:195], v17 offset:24576
    ds_read_b64_tr_b16 v[196:197], v18 offset:24576
    ds_read_b64_tr_b16 v[198:199], v19 offset:24576
    s_waitcnt lgkmcnt(4)
    v_mfma_f32_32x32x16_bf16 v[160:175], v[200:203], v[116:119], v[160:175]
    v_mfma_f32_32x32x16_bf16 v[176:191], v[204:207], v[116:119], v[176:191]
    ds_read_b64_tr_b16 v[200:201], v16 offset:28672
    ds_read_b64_tr_b16 v[202:203], v17 offset:28672
    ds_read_b64_tr_b16 v[204:205], v18 offset:28672
    ds_read_b64_tr_b16 v[206:207], v19 offset:28672
    s_waitcnt lgkmcnt(4)
    v_mfma_f32_32x32x16_bf16 v[160:175], v[192:195], v[120:123], v[160:175]
    v_mfma_f32_32x32x16_bf16 v[176:191], v[196:199], v[120:123], v[176:191]
    ds_read_b64_tr_b16 v[192:193], v16 offset:32768
    ds_read_b64_tr_b16 v[194:195], v17 offset:32768
    ds_read_b64_tr_b16 v[196:197], v18 offset:32768
    ds_read_b64_tr_b16 v[198:199], v19 offset:32768
    s_waitcnt lgkmcnt(4)
    v_mfma_f32_32x32x16_bf16 v[160:175], v[200:203], v[124:127], v[160:175]
    v_mfma_f32_32x32x16_bf16 v[176:191], v[204:207], v[124:127], v[176:191]
    ds_read_b64_tr_b16 v[200:201], v16 offset:36864
    ds_read_b64_tr_b16 v[202:203], v17 offset:36864
    ds_read_b64_tr_b16 v[204:205], v18 offset:36864
    ds_read_b64_tr_b16 v[206:207], v19 offset:36864
    s_waitcnt lgkmcnt(4)
    v_mfma_f32_32x32x16_bf16 v[160:175], v[192:195], v[128:131], v[160:175]
    v_mfma_f32_32x32x16_bf16 v[176:191], v[196:199], v[128:131], v[176:191]
    ds_read_b64_tr_b16 v[192:193], v16 offset:40960
    ds_read_b64_tr_b16 v[194:195], v17 offset:40960
    ds_read_b64_tr_b16 v[196:197], v18 offset:40960
    ds_read_b64_tr_b16 v[198:199], v19 offset:40960
    s_waitcnt lgkmcnt(4)
    v_mfma_f32_32x32x16_bf16 v[160:175], v[200:203], v[132:135], v[160:175]
    v_mfma_f32_32x32x16_bf16 v[176:191], v[204:207], v[132:135], v[176:191]
    ds_read_b64_tr_b16 v[200:201], v16 offset:45056
    ds_read_b64_tr_b16 v[202:203], v17 offset:45056
    ds_read_b64_tr_b16 v[204:205], v18 offset:45056
    ds_read_b64_tr_b16 v[206:207], v19 offset:45056
    s_waitcnt lgkmcnt(4)
    v_mfma_f32_32x32x16_bf16 v[160:175], v[192:195], v[136:139], v[160:175]
    v_mfma_f32_32x32x16_bf16 v[176:191], v[196:199], v[136:139], v[176:191]
    ds_read_b64_tr_b16 v[192:193], v16 offset:49152
    ds_read_b64_tr_b16 v[194:195], v17 offset:49152
    ds_read_b64_tr_b16 v[196:197], v18 offset:49152
    ds_read_b64_tr_b16 v[198:199], v19 offset:49152
    s_waitcnt lgkmcnt(4)
    v_mfma_f32_32x32x16_bf16 v[160:175], v[200:203], v[140:143], v[160:175]
    v_mfma_f32_32x32x16_bf16 v[176:191], v[204:207], v[140:143], v[176:191]
    ds_read_b64_tr_b16 v[200:201], v16 offset:53248
    ds_read_b64_tr_b16 v[202:203], v17 offset:53248
    ds_read_b64_tr_b16 v[204:205], v18 offset:53248
    ds_read_b64_tr_b16 v[206:207], v19 offset:53248
    s_waitcnt lgkmcnt(4)
    v_mfma_f32_32x32x16_bf16 v[160:175], v[192:195], v[144:147], v[160:175]
    v_mfma_f32_32x32x16_bf16 v[176:191], v[196:199], v[144:147], v[176:191]
    ds_read_b64_tr_b16 v[192:193], v16 offset:57344
    ds_read_b64_tr_b16 v[194:195], v17 offset:57344
    ds_read_b64_tr_b16 v[196:197], v18 offset:57344
    ds_read_b64_tr_b16 v[198:199], v19 offset:57344
    s_waitcnt lgkmcnt(4)
    v_mfma_f32_32x32x16_bf16 v[160:175], v[200:203], v[148:151], v[160:175]
    v_mfma_f32_32x32x16_bf16 v[176:191], v[204:207], v[148:151], v[176:191]
    ds_read_b64_tr_b16 v[200:201], v16 offset:61440
    ds_read_b64_tr_b16 v[202:203], v17 offset:61440
    ds_read_b64_tr_b16 v[204:205], v18 offset:61440
    ds_read_b64_tr_b16 v[206:207], v19 offset:61440
    s_waitcnt lgkmcnt(4)
    v_mfma_f32_32x32x16_bf16 v[160:175], v[192:195], v[152:155], v[160:175]
    v_mfma_f32_32x32x16_bf16 v[176:191], v[196:199], v[152:155], v[176:191]
    s_waitcnt lgkmcnt(0)
    v_mfma_f32_32x32x16_bf16 v[160:175], v[200:203], v[156:159], v[160:175]
    v_mfma_f32_32x32x16_bf16 v[176:191], v[204:207], v[156:159], v[176:191]
    s_nop 15
    s_nop 3
    s_and_b32 s3, s24, 3
    s_lshl_b32 s3, s3, 5
    v_and_b32 v4, 31, v1
    v_add_u32 v4, s3, v4
    v_lshrrev_b32 v5, 5, v1
    s_lshr_b32 s3, s24, 2
    s_lshl_b32 s3, s24, 13
    v_lshlrev_b32 v4, 4, v1
    v_add_u32 v4, s3, v4
    s_mov_b32 s29, 0
    buffer_store_dwordx4 v[160:163], v4, s[12:15], s29 offen
    s_mov_b32 s29, 1024
    buffer_store_dwordx4 v[164:167], v4, s[12:15], s29 offen
    s_mov_b32 s29, 2048
    buffer_store_dwordx4 v[168:171], v4, s[12:15], s29 offen
    s_mov_b32 s29, 3072
    buffer_store_dwordx4 v[172:175], v4, s[12:15], s29 offen
    s_mov_b32 s29, 4096
    buffer_store_dwordx4 v[176:179], v4, s[12:15], s29 offen
    s_mov_b32 s29, 5120
    buffer_store_dwordx4 v[180:183], v4, s[12:15], s29 offen
    s_mov_b32 s29, 6144
    buffer_store_dwordx4 v[184:187], v4, s[12:15], s29 offen
    s_mov_b32 s29, 7168
    buffer_store_dwordx4 v[188:191], v4, s[12:15], s29 offen
oproj_kernel_done:
    s_endpgm
.section .rodata,"a"
.p2align 6
.amdhsa_kernel oproj_kernel
  .amdhsa_next_free_vgpr 216
  .amdhsa_next_free_sgpr 40
  .amdhsa_accum_offset 216
  .amdhsa_group_segment_fixed_size 0
  .amdhsa_kernarg_size 64
  .amdhsa_user_sgpr_count 2
  .amdhsa_user_sgpr_kernarg_segment_ptr 1
  .amdhsa_system_sgpr_workgroup_id_x 1
.end_amdhsa_kernel
.text
.p2align 8
reduce_kernel:
    s_cmp_ge_u32 s2, 512
    s_cbranch_scc1 reduce_kernel_done
    s_load_dwordx2 s[16:17], s[0:1], 40
    s_load_dwordx2 s[20:21], s[0:1], 56
    s_lshr_b32 s13, s2, 4
    s_and_b32 s14, s2, 15
    s_lshl_b32 s14, s14, 8
    v_add_u32 v1, s14, v0
    v_lshlrev_b32 v2, 4, v1
    s_lshl_b32 s15, s13, 19
    v_add_u32 v2, s15, v2
    v_and_b32 v3, 31, v1
    v_bfe_u32 v36, v1, 9, 2
    v_lshl_add_u32 v3, v36, 5, v3
    v_cmp_gt_u32 vcc, 112, v3
    s_lshr_b32 s14, s13, 2
    s_mul_i32 s14, s14, 112
    v_add_u32 v3, s14, v3
    v_lshlrev_b32 v3, 10, v3
    s_and_b32 s14, s13, 3
    s_lshl_b32 s14, s14, 8
    v_add_u32 v3, s14, v3
    v_bfe_u32 v36, v1, 11, 1
    v_lshl_add_u32 v3, v36, 7, v3
    v_bfe_u32 v36, v1, 6, 3
    v_lshl_add_u32 v3, v36, 4, v3
    v_bfe_u32 v36, v1, 5, 1
    v_lshl_add_u32 v3, v36, 3, v3
    s_waitcnt lgkmcnt(0)
    s_add_u32 s20, s20, 16777216
    s_addc_u32 s21, s21, 0
    s_mov_b32 s4, s20
    s_and_b32 s5, s21, 0xffff
    s_mov_b32 s6, 16777216
    s_mov_b32 s7, 0x00020000
    s_mov_b32 s8, s16
    s_and_b32 s9, s17, 0xffff
    s_mov_b32 s10, 917504
    s_mov_b32 s11, 0x00020000
    s_mov_b32 s12, 0
    buffer_load_dwordx4 v[4:7], v2, s[4:7], s12 offen
    s_mov_b32 s12, 65536
    buffer_load_dwordx4 v[8:11], v2, s[4:7], s12 offen
    s_mov_b32 s12, 131072
    buffer_load_dwordx4 v[12:15], v2, s[4:7], s12 offen
    s_mov_b32 s12, 196608
    buffer_load_dwordx4 v[16:19], v2, s[4:7], s12 offen
    s_mov_b32 s12, 262144
    buffer_load_dwordx4 v[20:23], v2, s[4:7], s12 offen
    s_mov_b32 s12, 327680
    buffer_load_dwordx4 v[24:27], v2, s[4:7], s12 offen
    s_mov_b32 s12, 393216
    buffer_load_dwordx4 v[28:31], v2, s[4:7], s12 offen
    s_mov_b32 s12, 458752
    buffer_load_dwordx4 v[32:35], v2, s[4:7], s12 offen
    s_waitcnt vmcnt(0)
    v_add_f32 v4, v4, v8
    v_add_f32 v5, v5, v9
    v_add_f32 v6, v6, v10
    v_add_f32 v7, v7, v11
    v_add_f32 v4, v4, v12
    v_add_f32 v5, v5, v13
    v_add_f32 v6, v6, v14
    v_add_f32 v7, v7, v15
    v_add_f32 v4, v4, v16
    v_add_f32 v5, v5, v17
    v_add_f32 v6, v6, v18
    v_add_f32 v7, v7, v19
    v_add_f32 v4, v4, v20
    v_add_f32 v5, v5, v21
    v_add_f32 v6, v6, v22
    v_add_f32 v7, v7, v23
    v_add_f32 v4, v4, v24
    v_add_f32 v5, v5, v25
    v_add_f32 v6, v6, v26
    v_add_f32 v7, v7, v27
    v_add_f32 v4, v4, v28
    v_add_f32 v5, v5, v29
    v_add_f32 v6, v6, v30
    v_add_f32 v7, v7, v31
    v_add_f32 v4, v4, v32
    v_add_f32 v5, v5, v33
    v_add_f32 v6, v6, v34
    v_add_f32 v7, v7, v35
    s_and_saveexec_b64 s[14:15], vcc
    s_cbranch_execz reduce_kernel_done
    v_cvt_pk_bf16_f32 v4, v4, v5
    v_cvt_pk_bf16_f32 v5, v6, v7
    buffer_store_dwordx2 v[4:5], v3, s[8:11], 0 offen
reduce_kernel_done:
    s_endpgm
.section .rodata,"a"
.p2align 6
.amdhsa_kernel reduce_kernel
  .amdhsa_next_free_vgpr 40
  .amdhsa_next_free_sgpr 24
  .amdhsa_accum_offset 40
  .amdhsa_group_segment_fixed_size 0
  .amdhsa_kernarg_size 64
  .amdhsa_user_sgpr_count 2
  .amdhsa_user_sgpr_kernarg_segment_ptr 1
  .amdhsa_system_sgpr_workgroup_id_x 1
.end_amdhsa_kernel
.text
```
